```python
import torch

def _softmax(x, axis=-1):
    return torch.softmax(x, dim=axis)
def _gelu(x):
    return torch.nn.functional.gelu(x, approximate="tanh")
def _silu(x):
    return torch.nn.functional.silu(x)
def _sigmoid(x):
    return torch.sigmoid(x)
def _layernorm(x, axis=-1, eps=1e-5):
    m = x.mean(dim=axis, keepdim=True)
    v = x.var(dim=axis, keepdim=True, unbiased=False)
    return (x - m) / torch.sqrt(v + eps)
def _scatter_add(tgt, idx, src, axis=0):
    return tgt.clone().index_add_(axis, idx, src)
def _segment_sum(src, seg, n):
    out = torch.zeros((n,) + src.shape[1:], dtype=src.dtype)
    return out.index_add_(0, seg, src)
def _pad(x, pw):
    flat = tuple(v for pair in reversed(pw) for v in pair)
    return torch.nn.functional.pad(x, flat)

kernel_name = 'sequential_preLN__mha_block__moe_arch_mod__prompt'

def setup_inputs():

    _w = (lambda a: (lambda t: t.to(torch.bfloat16) if t.is_floating_point() else t)(torch.as_tensor(a)))
    def _A_setup():
        B, S, D, H = 1, 2048, 640, 32
        return {
            "x": _w((lambda *s: torch.randn(*s, dtype=torch.bfloat16) * 0.05)(B, S, D)),
            "wqkv": _w((lambda *s: torch.randn(*s, dtype=torch.bfloat16) * 0.05)(D, 3 * D)),
            "wo": _w((lambda *s: torch.randn(*s, dtype=torch.bfloat16) * 0.05)(D, D)),
        }
    _A_in = _A_setup()

    def _B_setup():
        B, S, D, F, C = 1, 2048, 640, 1536, 2
        return {
            "x": _w((lambda *s: torch.randn(*s, dtype=torch.bfloat16) * 0.05)(B, S, D)),
            "w_r": _w((lambda *s: torch.randn(*s, dtype=torch.bfloat16) * 0.05)(D)),
            "w_gate": _w((lambda *s: torch.randn(*s, dtype=torch.bfloat16) * 0.05)(D, F)),
            "w_up": _w((lambda *s: torch.randn(*s, dtype=torch.bfloat16) * 0.05)(D, F)),
            "w_down": _w((lambda *s: torch.randn(*s, dtype=torch.bfloat16) * 0.05)(F, D)),
        }
    _B_in = _B_setup()

    return {
        "A_x": _A_in["x"],
        "A_wqkv": _A_in["wqkv"],
        "A_wo": _A_in["wo"],
        "B_x": _B_in["x"],
        "B_w_r": _B_in["w_r"],
        "B_w_gate": _B_in["w_gate"],
        "B_w_up": _B_in["w_up"],
        "B_w_down": _B_in["w_down"],
    }

def reference(A_x, A_wqkv, A_wo, B_x, B_w_r, B_w_gate, B_w_up, B_w_down):
    def _A_ref(x, wqkv, wo):
        B, S, D = x.shape
        H = 32
        Dh = D // H
        qkv = (lambda x, *d: x.permute(*d))((x @ wqkv).reshape(B, S, 3, H, Dh), 2, 0, 3, 1, 4)
        q, k, v = qkv[0], qkv[1], qkv[2]
        scores = torch.einsum("bhqd,bhkd->bhqk", q, k) * (Dh ** -0.5)
        p = _softmax(scores, axis=-1)
        o = torch.einsum("bhqk,bhkd->bhqd", p, v)
        return (lambda x, *d: x.permute(*d))(o, 0, 2, 1, 3).reshape(B, S, D) @ wo

    def _B_ref(x, w_r, w_gate, w_up, w_down):
        B, S, D = x.shape
        C = 2
        r = x @ w_r
        idx = torch.argsort(-r, axis=-1)[:, :C]
        idx_e = (lambda x, n, axis: torch.repeat_interleave(x, n, dim=axis))(idx.reshape(B, C, 1), D, axis=2)
        x_sel = (lambda x, i, axis: torch.take_along_dim(x, i, dim=axis))(x, idx_e, axis=1)
        g = _silu(x_sel @ w_gate)
        u = x_sel @ w_up
        y = (g * u) @ w_down
        r_sel = _sigmoid((lambda x, i, axis: torch.take_along_dim(x, i, dim=axis))(r, idx, axis=1))
        y = y * r_sel.reshape(B, C, 1)
        b_off = (torch.arange(B) * S).reshape(B, 1)
        flat_idx = (idx + b_off).reshape(B * C)
        zero = (x * 0.0).reshape(B * S, D)
        upd = _scatter_add(zero, flat_idx, y.reshape(B * C, D), axis=0)
        return x + upd.reshape(B, S, D)

    x = A_x
    h = x + _A_ref(_layernorm(x, axis=-1), A_wqkv, A_wo)
    h2 = h + _B_ref(_layernorm(h, axis=-1), B_w_r, B_w_gate, B_w_up, B_w_down)
    return h2
```

```asm
; @launch grid=(256,1,1) block=(512,1,1) lds=163008
.amdgcn_target "amdgcn-amd-amdhsa--gfx950"
.text
.globl sequential_preLN__mha_block__moe_arch_mod__prompt_kernel
.p2align 8
.type sequential_preLN__mha_block__moe_arch_mod__prompt_kernel,@function
sequential_preLN__mha_block__moe_arch_mod__prompt_kernel:
    s_cmp_ge_u32 s2, 256
    s_cbranch_scc1 L_exit
    s_load_dwordx16 s[64:79], s[0:1], 0
    s_load_dwordx4 s[80:83], s[0:1], 64
    s_load_dwordx2 s[84:85], s[0:1], 80
    v_lshrrev_b32 v1, 6, v0
    v_and_b32 v0, 63, v0
    s_and_b32 s33, s2, 7
    v_readfirstlane_b32 s20, v1
    s_lshr_b32 s32, s2, 3
    s_sub_u32 s28, s20, 1
    s_cmp_lt_u32 s28, 2
    s_cbranch_scc0 A_c2
    s_getpc_b64 s[40:41]
A_pc:
    s_lshl_b32 s29, s32, 3
    s_mov_b64 exec, 0xff
    s_cmp_eq_u32 s28, 0
    s_cbranch_scc1 A_c3
    s_cmp_lt_u32 s32, 2
    s_cbranch_scc0 A_c4
    s_mov_b32 s29, 0
    s_mov_b64 exec, -1
A_c3:
    v_add_u32 v16, s29, v0
    v_lshlrev_b32 v16, 7, v16
    v_min_u32 v16, L_end - A_pc - 4, v16
    global_load_dword v236, v16, s[40:41]
A_c4:
    s_mov_b64 exec, -1
A_c2:
    s_lshr_b32 s21, s32, 1
    s_and_b32 s22, s32, 1
    s_mov_b32 s6, 2621440
    s_mov_b32 s7, 0x20000
    s_mov_b32 s10, 2457600
    s_mov_b32 s11, 0x20000
    s_mov_b32 s14, 256
    s_mov_b32 s15, 0x20000
    s_mov_b32 s18, 14680064
    s_mov_b32 s19, 0x20000
    s_getreg_b32 s3, hwreg(HW_REG_XCC_ID, 0, 3)
    s_cmp_lt_u32 s20, 4
    s_cbranch_scc1 A_consumer
    s_sub_u32 s26, s20, 4
    s_mul_i32 s52, s21, 2
    s_mul_i32 s28, s22, 0
    s_add_u32 s52, s52, s28
    s_mul_i32 s28, s33, 2
    s_add_u32 s52, s52, s28
    s_mul_i32 s28, s52, 6554
    s_lshr_b32 s28, s28, 16
    s_mul_i32 s28, s28, 10
    s_sub_u32 s52, s52, s28
    s_xor_b32 s44, s22, s21
    s_and_b32 s44, s44, 1
    v_lshrrev_b32 v1, 3, v0
    v_and_b32 v2, 7, v0
    v_lshrrev_b32 v3, 1, v1
    v_xor_b32 v2, v2, v3
    s_lshl_b32 s28, s21, 7
    s_lshl_b32 s29, s26, 5
    s_add_u32 s28, s28, s29
    v_add_u32 v1, s28, v1
    v_mul_u32_u24 v1, 1280, v1
    v_xor_b32 v3, 4, v2
    v_lshl_add_u32 v16, v2, 4, v1
    v_lshl_add_u32 v17, v3, 4, v1
    v_add_u32 v18, 18432, v16
    v_add_u32 v17, 9216, v17
    v_add_u32 v19, 18432, v17
    v_lshrrev_b32 v1, 4, v0
    v_and_b32 v2, 15, v0
    v_lshlrev_b32 v3, 1, v1
    v_xor_b32 v2, v2, v3
    v_xor_b32 v3, 8, v2
    s_mul_i32 s28, s33, 160
    s_mul_i32 s29, s22, 1280
    s_add_u32 s29, s29, s28
    s_mul_i32 s30, s22, 80
    s_add_u32 s30, s30, s28
    s_add_u32 s30, s30, 2400
    v_mov_b32 v4, s29
    v_mov_b32 v5, s30
    v_cmp_gt_u32 vcc, 10, v2
    v_cmp_gt_u32 s[34:35], 10, v3
    v_min_u32 v2, 14, v2
    v_min_u32 v3, 14, v3
    v_cndmask_b32 v6, v5, v4, vcc
    v_cndmask_b32 v7, v5, v4, s[34:35]
    v_lshl_add_u32 v6, v2, 4, v6
    v_lshl_add_u32 v7, v3, 4, v7
    s_lshl_b32 s28, s26, 4
    v_add_u32 v1, s28, v1
    v_mul_u32_u24 v1, 3840, v1
    v_add_u32 v20, v6, v1
    v_add_u32 v22, v7, v1
    v_add_u32 v21, 14336, v20
    v_add_u32 v23, 43008, v22
    v_add_u32 v22, 28672, v22
    s_lshl_b32 s53, s26, 12
    s_mov_b32 s54, s26
    s_waitcnt lgkmcnt(0)
    s_mov_b32 s4, s64
    s_and_b32 s5, s65, 0xffff
    s_mov_b32 s8, s66
    s_and_b32 s9, s67, 0xffff
    s_mov_b32 s12, s82
    s_and_b32 s13, s83, 0xffff
    s_mov_b32 s16, s84
    s_and_b32 s17, s85, 0xffff
    s_xor_b32 s29, s52, s44
    s_lshl_b32 s28, s29, 7
    s_mul_i32 s29, s29, 245760
    s_add_u32 m0, s53, 0
    s_add_u32 s52, s52, 1
    buffer_load_dwordx4 v16, s[4:7], s28 offen offset:0  lds
    buffer_load_dwordx4 v17, s[4:7], s28 offen offset:1024  lds
    buffer_load_dwordx4 v18, s[4:7], s28 offen offset:2048  lds
    buffer_load_dwordx4 v19, s[4:7], s28 offen offset:3072  lds
    s_add_u32 m0, s53, 16384
    s_cmp_eq_u32 s52, 10
    buffer_load_dwordx4 v20, s[8:11], s29 offen offset:0  lds
    buffer_load_dwordx4 v21, s[8:11], s29 offen offset:1024  lds
    buffer_load_dwordx4 v22, s[8:11], s29 offen offset:2048  lds
    buffer_load_dwordx4 v23, s[8:11], s29 offen offset:3072  lds
    s_cselect_b32 s52, 0, s52
    s_lshl_b32 s34, s33, 2
    s_and_b32 s35, s32, 3
    s_add_u32 s34, s34, s35
    s_lshr_b32 s35, s34, 1
    s_mul_i32 s35, s35, 163840
    s_lshr_b32 s36, s32, 2
    s_lshl_b32 s37, s36, 1
    s_and_b32 s38, s34, 1
    s_add_u32 s37, s37, s38
    s_lshl_b32 s38, s37, 2
    s_add_u32 s38, s38, s26
    s_mul_i32 s45, s38, 2560
    s_add_u32 s45, s45, s35
    s_lshr_b32 s46, s38, 5
    s_mul_i32 s46, s46, 81920
    s_and_b32 s38, s38, 31
    s_mul_i32 s38, s38, 512
    s_add_u32 s46, s46, s38
    s_add_u32 s46, s46, s35
    s_add_u32 s46, s46, 2621440
    s_lshl_b32 s36, s36, 2
    s_add_u32 s36, s36, s26
    s_lshr_b32 s47, s36, 4
    s_mul_i32 s47, s47, 40960
    s_and_b32 s36, s36, 15
    s_mul_i32 s36, s36, 512
    s_add_u32 s47, s47, s36
    s_mul_i32 s34, s34, 81920
    s_add_u32 s47, s47, s34
    s_add_u32 s47, s47, 5242880
    s_lshl_b32 s21, s33, 2
    s_and_b32 s22, s32, 3
    s_add_u32 s21, s21, s22
    s_lshr_b32 s22, s32, 2
    s_lshr_b32 s23, s21, 1
    s_and_b32 s26, s21, 1
    s_mul_i32 s27, s23, 163840
    s_lshr_b32 s30, s20, 2
    s_and_b32 s31, s20, 3
    s_mul_i32 s55, s30, 18432
    s_mul_i32 s42, s31, 2304
    s_add_u32 s55, s55, s42
    s_add_u32 s55, s55, 123008
    s_sub_u32 s23, s32, 24
    s_cmp_lt_u32 s23, 5
    s_cselect_b32 s23, 2, 0
    s_cmp_lt_u32 s32, 24
    s_cselect_b32 s23, 1, s23
    v_lshlrev_b32 v240, 4, v0
    v_and_b32 v10, 31, v0
    v_lshlrev_b32 v11, 4, v10
    v_lshrrev_b32 v12, 5, v0
    s_mul_i32 s42, s26, 1536
    v_add_u32 v208, s42, v240
    v_mul_u32_u24 v13, 2560, v12
    s_lshl_b32 s43, s26, 3
    s_add_u32 s43, s43, 1024
    v_add3_u32 v209, v13, v11, s43
    v_xor_b32 v13, s30, v12
    v_xor_b32 v13, 1, v13
    v_mul_u32_u24 v13, 2560, v13
    v_add3_u32 v239, v13, v11, s43
    v_lshlrev_b32 v13, 3, v10
    v_lshl_add_u32 v228, v12, 2, v13
    v_cmp_lt_u32 vcc, 19, v10
    v_mul_u32_u24 v13, 320, v12
    v_add_u32 v13, v13, v11
    v_cndmask_b32 v14, 0, 32, vcc
    v_sub_u32 v210, v13, v14
    v_and_b32 v13, 27, v10
    v_cmp_eq_u32 vcc, 18, v13
    v_mov_b32 v14, 0x3f803f80
    v_mov_b32 v211, 0xdddddddd
    v_cndmask_b32 v14, 0, v14, vcc
    v_mul_u32_u24 v13, 26, v0
    v_lshrrev_b32 v13, 8, v13
    v_mul_u32_u24 v13, 1120, v13
    s_mul_i32 s24, s22, 160
    v_add3_u32 v212, v13, v240, s24
    v_and_b32 v241, 15, v0
    v_lshrrev_b32 v242, 4, v0
    s_lshl_b32 s42, s21, 6
    s_lshl_b32 s43, s31, 4
    s_add_u32 s42, s42, s43
    v_add_u32 v243, s42, v241
    v_mul_u32_u24 v13, 40, v242
    v_add_u32 v218, s24, v13
    v_mul_u32_u24 v13, 1280, v243
    v_add_u32 v244, v13, v218
    s_mul_i32 s42, s30, 18432
    s_add_u32 s42, s42, 123008
    v_add_u32 v213, s42, v240
    s_add_u32 s42, s42, 1024
    v_add_u32 v214, s42, v210
    s_lshl_b32 s42, s30, 2
    s_add_u32 s42, s42, 159908
    v_mov_b32 v215, s42
    v_mov_b32 v231, 159916
    v_lshlrev_b32 v216, 2, v0
    v_mov_b32 v227, 1
    s_xor_b32 s42, s30, 1
    s_mul_i32 s42, s42, 18432
    s_mul_i32 s43, s31, 2304
    s_add_u32 s42, s42, s43
    s_add_u32 s42, s42, 123008
    v_add_u32 v223, s55, v240
    v_add_u32 v225, s42, v240
    v_lshlrev_b32 v13, 2, v10
    v_add_u32 v229, s55, v13
    v_add_u32 v230, s42, v13
    v_cmp_gt_u32 vcc, 16, v0
    s_mul_i32 s43, s20, 384
    s_add_u32 s43, s43, 157632
    v_mov_b32 v11, s43
    v_mov_b32 v12, s55
    v_cndmask_b32 v11, v11, v12, vcc
    v_lshl_add_u32 v224, v0, 3, v11
    s_xor_b32 s43, s20, 4
    s_mul_i32 s43, s43, 384
    s_add_u32 s43, s43, 157632
    v_mov_b32 v11, s43
    v_mov_b32 v12, s42
    v_cndmask_b32 v11, v11, v12, vcc
    v_lshl_add_u32 v226, v0, 3, v11
    s_lshl_b32 s42, s32, 3
    s_add_u32 s42, s42, s20
    s_mul_i32 s43, s42, 3200
    v_min_u32 v11, 24, v0
    v_lshl_add_u32 v219, v11, 7, s43
    s_lshr_b32 s43, s42, 5
    s_mul_i32 s43, s43, 245760
    s_and_b32 s42, s42, 31
    s_mul_i32 s42, s42, 2560
    s_add_u32 s43, s43, s42
    s_mul_i32 s24, s33, 160
    s_and_b32 s24, s24, 0xffffff80
    s_add_u32 s43, s43, s24
    v_min_u32 v11, 3, v0
    v_lshrrev_b32 v12, 1, v11
    v_mul_u32_u24 v12, 1024, v12
    v_lshl_add_u32 v11, v11, 7, v12
    v_add_u32 v221, s43, v11
    s_lshl_b32 s42, s32, 2
    s_add_u32 s42, s42, s31
    s_mul_i32 s42, s42, 6144
    s_mul_i32 s43, s33, 384
    s_add_u32 s42, s42, s43
    v_min_u32 v11, 5, v0
    v_mul_u32_u24 v12, 86, v11
    v_lshrrev_b32 v12, 8, v12
    v_mul_u32_u24 v12, 2688, v12
    v_lshl_add_u32 v11, v11, 7, v12
    v_add_u32 v220, s42, v11
    s_min_u32 s42, s20, 6
    s_lshl_b32 s42, s42, 11
    v_lshl_add_u32 v234, v0, 3, s42
    s_lshl_b32 s42, s22, 1
    s_add_u32 s42, s42, s26
    s_lshl_b32 s42, s42, 3
    s_add_u32 s42, s42, s20
    s_mul_i32 s42, s42, 1280
    s_add_u32 s42, s42, s27
    s_add_u32 s42, s42, 2621440
    s_lshl_b32 s43, s22, 3
    s_add_u32 s43, s43, s20
    s_mul_i32 s43, s43, 1280
    s_mul_i32 s24, s21, 81920
    s_add_u32 s43, s43, s24
    s_add_u32 s43, s43, 5241600
    v_cmp_gt_u32 vcc, 10, v0
    v_mov_b32 v11, s43
    v_mov_b32 v12, s42
    v_cndmask_b32 v11, v11, v12, vcc
    v_min_u32 v12, 19, v0
    v_lshl_add_u32 v237, v12, 7, v11
    v_and_b32 v11, 7, v0
    v_lshlrev_b32 v238, 2, v11
    v_bfe_u32 v2, v0, 2, 2
    v_and_b32 v3, 3, v0
    v_mul_u32_u24 v3, 40, v3
    v_lshrrev_b32 v4, 1, v242
    v_mul_u32_u24 v5, 20, v4
    v_and_b32 v6, 1, v242
    v_lshl_add_u32 v5, v6, 2, v5
    s_mul_i32 s43, s30, 320
    v_add3_u32 v5, v5, v2, s43
    v_mul_u32_u24 v5, 160, v5
    s_and_b32 s24, s22, 1
    s_mul_i32 s42, s24, 25600
    v_add3_u32 v252, v5, v3, s42
    v_mul_u32_u24 v5, 40, v242
    s_add_u32 s43, s43, 16
    v_add3_u32 v5, v5, v2, s43
    v_mul_u32_u24 v5, 160, v5
    v_add_u32 v253, v5, v3
    s_lshr_b32 s42, s21, 2
    s_mul_i32 s42, s42, 14336
    s_lshl_b32 s43, s21, 1
    s_lshr_b32 s24, s31, 1
    s_add_u32 s43, s43, s24
    s_and_b32 s43, s43, 7
    s_mul_i32 s43, s43, 1280
    s_add_u32 s42, s42, s43
    s_mul_i32 s43, s30, 1835008
    s_add_u32 s42, s42, s43
    s_and_b32 s43, s31, 1
    s_lshl_b32 s43, s43, 4
    v_add_u32 v5, s43, v241
    v_mul_u32_u24 v4, 114688, v4
    v_lshl_add_u32 v4, v6, 9, v4
    v_lshl_add_u32 v2, v5, 4, v4
    s_and_b32 s24, s22, 1
    s_mul_i32 s24, s24, 917504
    s_add_u32 s24, s24, s42
    v_add_u32 v254, s24, v2
    v_mul_u32_u24 v4, 229376, v242
    v_lshl_add_u32 v3, v5, 3, v4
    v_add_u32 v255, s42, v3
    s_mul_i32 s42, s33, 24
    s_add_u32 s42, s42, s32
    s_lshl_b32 s42, s42, 4
    s_mul_i32 s43, s31, 196608
    s_add_u32 s42, s42, s43
    v_mul_u32_u24 v11, 3072, v0
    v_add_u32 v217, s42, v11
    s_cmp_eq_u32 s23, 2
    s_cbranch_scc0 S_nf2L
    s_mul_i32 s42, s33, 5
    s_add_u32 s42, s42, s32
    s_sub_u32 s42, s42, 24
    s_lshl_b32 s42, s42, 5
    s_mul_i32 s43, s20, 245760
    s_add_u32 s42, s42, s43
    v_lshrrev_b32 v11, 1, v0
    v_mul_u32_u24 v11, 1280, v11
    v_and_b32 v12, 1, v0
    v_lshl_add_u32 v11, v12, 4, v11
    v_add_u32 v217, s42, v11
S_nf2L:
    v_bfe_u32 v11, v0, 2, 2
    v_lshl_add_u32 v11, v242, 3, v11
    v_lshlrev_b32 v11, 5, v11
    v_and_b32 v12, 3, v0
    v_lshl_add_u32 v11, v12, 3, v11
    s_mul_i32 s42, s20, 2560
    s_add_u32 s42, s42, 102400
    v_add_u32 v222, s42, v11
    v_mov_b32 v160, v14
    v_mov_b32 v161, v14
    v_mov_b32 v162, v14
    v_mov_b32 v163, v14
    v_mov_b32 v164, v14
    v_mov_b32 v165, v14
    v_mov_b32 v166, v14
    v_mov_b32 v167, v14
    v_mov_b32 v168, v14
    v_mov_b32 v169, v14
    v_mov_b32 v170, v14
    v_mov_b32 v171, v14
    v_mov_b32 v172, v14
    v_mov_b32 v173, v14
    v_mov_b32 v174, v14
    v_mov_b32 v175, v14
    v_mov_b32 v176, 0
    v_mov_b32 v177, 0
    v_mov_b32 v178, 0
    v_mov_b32 v179, 0
    v_mov_b32 v180, 0
    v_mov_b32 v181, 0
    v_mov_b32 v182, 0
    v_mov_b32 v183, 0
    v_mov_b32 v184, 0
    v_mov_b32 v185, 0
    v_mov_b32 v186, 0
    v_mov_b32 v187, 0
    v_mov_b32 v188, 0
    v_mov_b32 v189, 0
    v_mov_b32 v190, 0
    v_mov_b32 v191, 0
    v_mov_b32 v192, 0
    v_mov_b32 v193, 0
    v_mov_b32 v194, 0
    v_mov_b32 v195, 0
    v_mov_b32 v196, 0
    v_mov_b32 v197, 0
    v_mov_b32 v198, 0
    v_mov_b32 v199, 0
    v_mov_b32 v200, 0
    v_mov_b32 v201, 0
    v_mov_b32 v202, 0
    v_mov_b32 v203, 0
    v_mov_b32 v204, 0
    v_mov_b32 v205, 0
    v_mov_b32 v206, 0
    v_mov_b32 v207, 0
    s_cmp_lt_u32 s20, 5
    s_cselect_b32 s42, 0x80000000, -1
    v_mov_b32 v232, s42
    v_mov_b32 v233, s42
    s_xor_b32 s29, s52, s44
    s_lshl_b32 s28, s29, 7
    s_mul_i32 s29, s29, 245760
    s_add_u32 m0, s53, 32768
    s_add_u32 s52, s52, 1
    buffer_load_dwordx4 v16, s[4:7], s28 offen offset:0  lds
    buffer_load_dwordx4 v17, s[4:7], s28 offen offset:1024  lds
    buffer_load_dwordx4 v18, s[4:7], s28 offen offset:2048  lds
    buffer_load_dwordx4 v19, s[4:7], s28 offen offset:3072  lds
    s_add_u32 m0, s53, 49152
    s_cmp_eq_u32 s52, 10
    buffer_load_dwordx4 v20, s[8:11], s29 offen offset:0  lds
    buffer_load_dwordx4 v21, s[8:11], s29 offen offset:1024  lds
    buffer_load_dwordx4 v22, s[8:11], s29 offen offset:2048  lds
    buffer_load_dwordx4 v23, s[8:11], s29 offen offset:3072  lds
    s_cselect_b32 s52, 0, s52
    s_waitcnt vmcnt(8)
    s_barrier
    s_xor_b32 s29, s52, s44
    s_lshl_b32 s28, s29, 7
    s_mul_i32 s29, s29, 245760
    s_add_u32 m0, s53, 65536
    s_add_u32 s52, s52, 1
    buffer_load_dwordx4 v16, s[4:7], s28 offen offset:0  lds
    buffer_load_dwordx4 v17, s[4:7], s28 offen offset:1024  lds
    buffer_load_dwordx4 v18, s[4:7], s28 offen offset:2048  lds
    buffer_load_dwordx4 v19, s[4:7], s28 offen offset:3072  lds
    s_add_u32 m0, s53, 81920
    s_cmp_eq_u32 s52, 10
    buffer_load_dwordx4 v20, s[8:11], s29 offen offset:0  lds
    buffer_load_dwordx4 v21, s[8:11], s29 offen offset:1024  lds
    buffer_load_dwordx4 v22, s[8:11], s29 offen offset:2048  lds
    buffer_load_dwordx4 v23, s[8:11], s29 offen offset:3072  lds
    s_cselect_b32 s52, 0, s52
    s_buffer_load_dwordx2 s[70:71], s[16:19], s45 offset:60
    s_buffer_load_dwordx2 s[70:71], s[16:19], s45 offset:188
    s_buffer_load_dwordx2 s[70:71], s[16:19], s45 offset:316
    s_buffer_load_dwordx2 s[70:71], s[16:19], s45 offset:444
    s_waitcnt vmcnt(8)
    s_barrier
    s_xor_b32 s29, s52, s44
    s_lshl_b32 s28, s29, 7
    s_mul_i32 s29, s29, 245760
    s_add_u32 m0, s53, 98304
    s_add_u32 s52, s52, 1
    buffer_load_dwordx4 v16, s[4:7], s28 offen offset:0  lds
    buffer_load_dwordx4 v17, s[4:7], s28 offen offset:1024  lds
    buffer_load_dwordx4 v18, s[4:7], s28 offen offset:2048  lds
    buffer_load_dwordx4 v19, s[4:7], s28 offen offset:3072  lds
    s_add_u32 m0, s53, 114688
    s_cmp_eq_u32 s52, 10
    buffer_load_dwordx4 v20, s[8:11], s29 offen offset:0  lds
    buffer_load_dwordx4 v21, s[8:11], s29 offen offset:1024  lds
    buffer_load_dwordx4 v22, s[8:11], s29 offen offset:2048  lds
    buffer_load_dwordx4 v23, s[8:11], s29 offen offset:3072  lds
    s_cselect_b32 s52, 0, s52
    s_buffer_load_dwordx2 s[70:71], s[16:19], s45 offset:572
    s_buffer_load_dwordx2 s[70:71], s[16:19], s45 offset:700
    s_buffer_load_dwordx2 s[70:71], s[16:19], s45 offset:828
    s_buffer_load_dwordx2 s[70:71], s[16:19], s45 offset:956
    s_waitcnt vmcnt(8)
    s_barrier
    s_xor_b32 s29, s52, s44
    s_lshl_b32 s28, s29, 7
    s_mul_i32 s29, s29, 245760
    s_add_u32 m0, s53, 0
    s_add_u32 s52, s52, 1
    buffer_load_dwordx4 v16, s[4:7], s28 offen offset:0  lds
    buffer_load_dwordx4 v17, s[4:7], s28 offen offset:1024  lds
    buffer_load_dwordx4 v18, s[4:7], s28 offen offset:2048  lds
    buffer_load_dwordx4 v19, s[4:7], s28 offen offset:3072  lds
    s_add_u32 m0, s53, 16384
    s_cmp_eq_u32 s52, 10
    buffer_load_dwordx4 v20, s[8:11], s29 offen offset:0  lds
    buffer_load_dwordx4 v21, s[8:11], s29 offen offset:1024  lds
    buffer_load_dwordx4 v22, s[8:11], s29 offen offset:2048  lds
    buffer_load_dwordx4 v23, s[8:11], s29 offen offset:3072  lds
    s_cselect_b32 s52, 0, s52
    s_buffer_load_dwordx2 s[70:71], s[16:19], s45 offset:1084
    s_buffer_load_dwordx2 s[70:71], s[16:19], s45 offset:1212
    s_buffer_load_dwordx2 s[70:71], s[16:19], s45 offset:1340
    s_buffer_load_dwordx2 s[70:71], s[16:19], s45 offset:1468
    s_waitcnt vmcnt(8)
    s_barrier
    s_xor_b32 s29, s52, s44
    s_lshl_b32 s28, s29, 7
    s_mul_i32 s29, s29, 245760
    s_add_u32 m0, s53, 32768
    s_add_u32 s52, s52, 1
    buffer_load_dwordx4 v16, s[4:7], s28 offen offset:0  lds
    buffer_load_dwordx4 v17, s[4:7], s28 offen offset:1024  lds
    buffer_load_dwordx4 v18, s[4:7], s28 offen offset:2048  lds
    buffer_load_dwordx4 v19, s[4:7], s28 offen offset:3072  lds
    s_add_u32 m0, s53, 49152
    s_cmp_eq_u32 s52, 10
    buffer_load_dwordx4 v20, s[8:11], s29 offen offset:0  lds
    buffer_load_dwordx4 v21, s[8:11], s29 offen offset:1024  lds
    buffer_load_dwordx4 v22, s[8:11], s29 offen offset:2048  lds
    buffer_load_dwordx4 v23, s[8:11], s29 offen offset:3072  lds
    s_cselect_b32 s52, 0, s52
    s_buffer_load_dwordx2 s[70:71], s[16:19], s45 offset:1596
    s_buffer_load_dwordx2 s[70:71], s[16:19], s45 offset:1724
    s_buffer_load_dwordx2 s[70:71], s[16:19], s45 offset:1852
    s_buffer_load_dwordx2 s[70:71], s[16:19], s45 offset:1980
    s_waitcnt vmcnt(8)
    s_barrier
    s_xor_b32 s29, s52, s44
    s_lshl_b32 s28, s29, 7
    s_mul_i32 s29, s29, 245760
    s_add_u32 m0, s53, 65536
    s_add_u32 s52, s52, 1
    buffer_load_dwordx4 v16, s[4:7], s28 offen offset:0  lds
    buffer_load_dwordx4 v17, s[4:7], s28 offen offset:1024  lds
    buffer_load_dwordx4 v18, s[4:7], s28 offen offset:2048  lds
    buffer_load_dwordx4 v19, s[4:7], s28 offen offset:3072  lds
    s_add_u32 m0, s53, 81920
    s_cmp_eq_u32 s52, 10
    buffer_load_dwordx4 v20, s[8:11], s29 offen offset:0  lds
    buffer_load_dwordx4 v21, s[8:11], s29 offen offset:1024  lds
    buffer_load_dwordx4 v22, s[8:11], s29 offen offset:2048  lds
    buffer_load_dwordx4 v23, s[8:11], s29 offen offset:3072  lds
    s_cselect_b32 s52, 0, s52
    s_buffer_load_dwordx2 s[70:71], s[16:19], s45 offset:2108
    s_buffer_load_dwordx2 s[70:71], s[16:19], s45 offset:2236
    s_buffer_load_dwordx2 s[70:71], s[16:19], s45 offset:2364
    s_buffer_load_dwordx2 s[70:71], s[16:19], s45 offset:2492
    s_waitcnt vmcnt(8)
    s_barrier
    s_xor_b32 s29, s52, s44
    s_lshl_b32 s28, s29, 7
    s_mul_i32 s29, s29, 245760
    s_add_u32 m0, s53, 98304
    s_add_u32 s52, s52, 1
    buffer_load_dwordx4 v16, s[4:7], s28 offen offset:0  lds
    buffer_load_dwordx4 v17, s[4:7], s28 offen offset:1024  lds
    buffer_load_dwordx4 v18, s[4:7], s28 offen offset:2048  lds
    buffer_load_dwordx4 v19, s[4:7], s28 offen offset:3072  lds
    s_add_u32 m0, s53, 114688
    s_cmp_eq_u32 s52, 10
    buffer_load_dwordx4 v20, s[8:11], s29 offen offset:0  lds
    buffer_load_dwordx4 v21, s[8:11], s29 offen offset:1024  lds
    buffer_load_dwordx4 v22, s[8:11], s29 offen offset:2048  lds
    buffer_load_dwordx4 v23, s[8:11], s29 offen offset:3072  lds
    s_cselect_b32 s52, 0, s52
    s_buffer_load_dwordx2 s[70:71], s[16:19], s46 offset:60
    s_buffer_load_dwordx2 s[70:71], s[16:19], s46 offset:188
    s_buffer_load_dwordx2 s[70:71], s[16:19], s46 offset:316
    s_buffer_load_dwordx2 s[70:71], s[16:19], s46 offset:444
    s_waitcnt vmcnt(8)
    s_barrier
    s_xor_b32 s29, s52, s44
    s_lshl_b32 s28, s29, 7
    s_mul_i32 s29, s29, 245760
    s_add_u32 m0, s53, 0
    s_add_u32 s52, s52, 1
    buffer_load_dwordx4 v16, s[4:7], s28 offen offset:0  lds
    buffer_load_dwordx4 v17, s[4:7], s28 offen offset:1024  lds
    buffer_load_dwordx4 v18, s[4:7], s28 offen offset:2048  lds
    buffer_load_dwordx4 v19, s[4:7], s28 offen offset:3072  lds
    s_add_u32 m0, s53, 16384
    s_cmp_eq_u32 s52, 10
    buffer_load_dwordx4 v20, s[8:11], s29 offen offset:0  lds
    buffer_load_dwordx4 v21, s[8:11], s29 offen offset:1024  lds
    buffer_load_dwordx4 v22, s[8:11], s29 offen offset:2048  lds
    buffer_load_dwordx4 v23, s[8:11], s29 offen offset:3072  lds
    s_cselect_b32 s52, 0, s52
    s_buffer_load_dwordx2 s[70:71], s[16:19], s47 offset:60
    s_buffer_load_dwordx2 s[70:71], s[16:19], s47 offset:188
    s_buffer_load_dwordx2 s[70:71], s[16:19], s47 offset:316
    s_buffer_load_dwordx2 s[70:71], s[16:19], s47 offset:444
    s_waitcnt vmcnt(8)
    s_barrier
    s_xor_b32 s29, s52, s44
    s_lshl_b32 s28, s29, 7
    s_mul_i32 s29, s29, 245760
    s_add_u32 m0, s53, 32768
    s_add_u32 s52, s52, 1
    buffer_load_dwordx4 v16, s[4:7], s28 offen offset:0  lds
    buffer_load_dwordx4 v17, s[4:7], s28 offen offset:1024  lds
    buffer_load_dwordx4 v18, s[4:7], s28 offen offset:2048  lds
    buffer_load_dwordx4 v19, s[4:7], s28 offen offset:3072  lds
    s_add_u32 m0, s53, 49152
    s_cmp_eq_u32 s52, 10
    buffer_load_dwordx4 v20, s[8:11], s29 offen offset:0  lds
    buffer_load_dwordx4 v21, s[8:11], s29 offen offset:1024  lds
    buffer_load_dwordx4 v22, s[8:11], s29 offen offset:2048  lds
    buffer_load_dwordx4 v23, s[8:11], s29 offen offset:3072  lds
    s_cselect_b32 s52, 0, s52
    s_waitcnt vmcnt(8)
    s_barrier
    s_waitcnt vmcnt(0)
    s_barrier
    s_barrier
    v_mov_b32 v2, 159888
    ds_read_b32 v2, v2
    s_waitcnt lgkmcnt(0)
    v_readfirstlane_b32 s3, v2
    s_branch B_setup
A_consumer:
    s_waitcnt lgkmcnt(0)
    s_mov_b32 s4, s64
    s_and_b32 s5, s65, 0xffff
    s_mov_b32 s8, s66
    s_and_b32 s9, s67, 0xffff
    s_mov_b32 s12, s82
    s_and_b32 s13, s83, 0xffff
    s_mov_b32 s16, s84
    s_and_b32 s17, s85, 0xffff
    s_lshl_b32 s36, s33, 13
    s_add_u32 s36, s36, 11534336
    s_lshl_b32 s37, s32, 7
    s_add_u32 s37, s37, s36
    s_lshl_b32 s38, s33, 2
    s_mov_b32 s39, 2
    s_or_b32 s28, s20, s32
    s_cbranch_scc1 A_c1
    v_mov_b32 v16, 0
    v_mov_b32 v17, 0
    v_mov_b32 v18, 0
    v_mov_b32 v19, 0
    v_lshlrev_b32 v20, 4, v0
    v_and_b32 v21, 31, v0
    v_lshlrev_b32 v21, 7, v21
    buffer_store_dwordx4 v[16:19], v20, s[16:19], s36 offen sc1
    buffer_store_dword v16, v21, s[16:19], s36 offen offset:1024 sc1
A_c1:
    s_lshl_b32 s21, s33, 2
    s_and_b32 s22, s32, 3
    s_add_u32 s21, s21, s22
    s_lshr_b32 s22, s32, 2
    s_lshr_b32 s23, s21, 1
    s_and_b32 s26, s21, 1
    s_mul_i32 s27, s23, 163840
    s_lshr_b32 s30, s20, 2
    s_and_b32 s31, s20, 3
    s_mul_i32 s55, s30, 18432
    s_mul_i32 s42, s31, 2304
    s_add_u32 s55, s55, s42
    s_add_u32 s55, s55, 123008
    s_sub_u32 s23, s32, 24
    s_cmp_lt_u32 s23, 5
    s_cselect_b32 s23, 2, 0
    s_cmp_lt_u32 s32, 24
    s_cselect_b32 s23, 1, s23
    v_lshlrev_b32 v240, 4, v0
    v_and_b32 v10, 31, v0
    v_lshlrev_b32 v11, 4, v10
    v_lshrrev_b32 v12, 5, v0
    s_mul_i32 s42, s26, 1536
    v_add_u32 v208, s42, v240
    v_mul_u32_u24 v13, 2560, v12
    s_lshl_b32 s43, s26, 3
    s_add_u32 s43, s43, 1024
    v_add3_u32 v209, v13, v11, s43
    v_xor_b32 v13, s30, v12
    v_xor_b32 v13, 1, v13
    v_mul_u32_u24 v13, 2560, v13
    v_add3_u32 v239, v13, v11, s43
    v_lshlrev_b32 v13, 3, v10
    v_lshl_add_u32 v228, v12, 2, v13
    v_cmp_lt_u32 vcc, 19, v10
    v_mul_u32_u24 v13, 320, v12
    v_add_u32 v13, v13, v11
    v_cndmask_b32 v14, 0, 32, vcc
    v_sub_u32 v210, v13, v14
    v_and_b32 v13, 27, v10
    v_cmp_eq_u32 vcc, 18, v13
    v_mov_b32 v14, 0x3f803f80
    v_mov_b32 v211, 0xdddddddd
    v_cndmask_b32 v14, 0, v14, vcc
    v_mul_u32_u24 v13, 26, v0
    v_lshrrev_b32 v13, 8, v13
    v_mul_u32_u24 v13, 1120, v13
    s_mul_i32 s24, s22, 160
    v_add3_u32 v212, v13, v240, s24
    v_and_b32 v241, 15, v0
    v_lshrrev_b32 v242, 4, v0
    s_lshl_b32 s42, s21, 6
    s_lshl_b32 s43, s31, 4
    s_add_u32 s42, s42, s43
    v_add_u32 v243, s42, v241
    v_mul_u32_u24 v13, 40, v242
    v_add_u32 v218, s24, v13
    v_mul_u32_u24 v13, 1280, v243
    v_add_u32 v244, v13, v218
    s_mul_i32 s42, s30, 18432
    s_add_u32 s42, s42, 123008
    v_add_u32 v213, s42, v240
    s_add_u32 s42, s42, 1024
    v_add_u32 v214, s42, v210
    s_lshl_b32 s42, s30, 2
    s_add_u32 s42, s42, 159908
    v_mov_b32 v215, s42
    v_mov_b32 v231, 159916
    v_lshlrev_b32 v216, 2, v0
    v_mov_b32 v227, 1
    s_xor_b32 s42, s30, 1
    s_mul_i32 s42, s42, 18432
    s_mul_i32 s43, s31, 2304
    s_add_u32 s42, s42, s43
    s_add_u32 s42, s42, 123008
    v_add_u32 v223, s55, v240
    v_add_u32 v225, s42, v240
    v_lshlrev_b32 v13, 2, v10
    v_add_u32 v229, s55, v13
    v_add_u32 v230, s42, v13
    v_cmp_gt_u32 vcc, 16, v0
    s_mul_i32 s43, s20, 384
    s_add_u32 s43, s43, 157632
    v_mov_b32 v11, s43
    v_mov_b32 v12, s55
    v_cndmask_b32 v11, v11, v12, vcc
    v_lshl_add_u32 v224, v0, 3, v11
    s_xor_b32 s43, s20, 4
    s_mul_i32 s43, s43, 384
    s_add_u32 s43, s43, 157632
    v_mov_b32 v11, s43
    v_mov_b32 v12, s42
    v_cndmask_b32 v11, v11, v12, vcc
    v_lshl_add_u32 v226, v0, 3, v11
    s_lshl_b32 s42, s32, 3
    s_add_u32 s42, s42, s20
    s_mul_i32 s43, s42, 3200
    v_min_u32 v11, 24, v0
    v_lshl_add_u32 v219, v11, 7, s43
    s_lshr_b32 s43, s42, 5
    s_mul_i32 s43, s43, 245760
    s_and_b32 s42, s42, 31
    s_mul_i32 s42, s42, 2560
    s_add_u32 s43, s43, s42
    s_mul_i32 s24, s33, 160
    s_and_b32 s24, s24, 0xffffff80
    s_add_u32 s43, s43, s24
    v_min_u32 v11, 3, v0
    v_lshrrev_b32 v12, 1, v11
    v_mul_u32_u24 v12, 1024, v12
    v_lshl_add_u32 v11, v11, 7, v12
    v_add_u32 v221, s43, v11
    s_lshl_b32 s42, s32, 2
    s_add_u32 s42, s42, s31
    s_mul_i32 s42, s42, 6144
    s_mul_i32 s43, s33, 384
    s_add_u32 s42, s42, s43
    v_min_u32 v11, 5, v0
    v_mul_u32_u24 v12, 86, v11
    v_lshrrev_b32 v12, 8, v12
    v_mul_u32_u24 v12, 2688, v12
    v_lshl_add_u32 v11, v11, 7, v12
    v_add_u32 v220, s42, v11
    s_min_u32 s42, s20, 6
    s_lshl_b32 s42, s42, 11
    v_lshl_add_u32 v234, v0, 3, s42
    s_lshl_b32 s42, s22, 1
    s_add_u32 s42, s42, s26
    s_lshl_b32 s42, s42, 3
    s_add_u32 s42, s42, s20
    s_mul_i32 s42, s42, 1280
    s_add_u32 s42, s42, s27
    s_add_u32 s42, s42, 2621440
    s_lshl_b32 s43, s22, 3
    s_add_u32 s43, s43, s20
    s_mul_i32 s43, s43, 1280
    s_mul_i32 s24, s21, 81920
    s_add_u32 s43, s43, s24
    s_add_u32 s43, s43, 5241600
    v_cmp_gt_u32 vcc, 10, v0
    v_mov_b32 v11, s43
    v_mov_b32 v12, s42
    v_cndmask_b32 v11, v11, v12, vcc
    v_min_u32 v12, 19, v0
    v_lshl_add_u32 v237, v12, 7, v11
    v_and_b32 v11, 7, v0
    v_lshlrev_b32 v238, 2, v11
    v_bfe_u32 v2, v0, 2, 2
    v_and_b32 v3, 3, v0
    v_mul_u32_u24 v3, 40, v3
    v_lshrrev_b32 v4, 1, v242
    v_mul_u32_u24 v5, 20, v4
    v_and_b32 v6, 1, v242
    v_lshl_add_u32 v5, v6, 2, v5
    s_mul_i32 s43, s30, 320
    v_add3_u32 v5, v5, v2, s43
    v_mul_u32_u24 v5, 160, v5
    s_and_b32 s24, s22, 1
    s_mul_i32 s42, s24, 25600
    v_add3_u32 v252, v5, v3, s42
    v_mul_u32_u24 v5, 40, v242
    s_add_u32 s43, s43, 16
    v_add3_u32 v5, v5, v2, s43
    v_mul_u32_u24 v5, 160, v5
    v_add_u32 v253, v5, v3
    s_lshr_b32 s42, s21, 2
    s_mul_i32 s42, s42, 14336
    s_lshl_b32 s43, s21, 1
    s_lshr_b32 s24, s31, 1
    s_add_u32 s43, s43, s24
    s_and_b32 s43, s43, 7
    s_mul_i32 s43, s43, 1280
    s_add_u32 s42, s42, s43
    s_mul_i32 s43, s30, 1835008
    s_add_u32 s42, s42, s43
    s_and_b32 s43, s31, 1
    s_lshl_b32 s43, s43, 4
    v_add_u32 v5, s43, v241
    v_mul_u32_u24 v4, 114688, v4
    v_lshl_add_u32 v4, v6, 9, v4
    v_lshl_add_u32 v2, v5, 4, v4
    s_and_b32 s24, s22, 1
    s_mul_i32 s24, s24, 917504
    s_add_u32 s24, s24, s42
    v_add_u32 v254, s24, v2
    v_mul_u32_u24 v4, 229376, v242
    v_lshl_add_u32 v3, v5, 3, v4
    v_add_u32 v255, s42, v3
    s_mul_i32 s42, s33, 24
    s_add_u32 s42, s42, s32
    s_lshl_b32 s42, s42, 4
    s_mul_i32 s43, s31, 196608
    s_add_u32 s42, s42, s43
    v_mul_u32_u24 v11, 3072, v0
    v_add_u32 v217, s42, v11
    s_cmp_eq_u32 s23, 2
    s_cbranch_scc0 S_nf2C
    s_mul_i32 s42, s33, 5
    s_add_u32 s42, s42, s32
    s_sub_u32 s42, s42, 24
    s_lshl_b32 s42, s42, 5
    s_mul_i32 s43, s20, 245760
    s_add_u32 s42, s42, s43
    v_lshrrev_b32 v11, 1, v0
    v_mul_u32_u24 v11, 1280, v11
    v_and_b32 v12, 1, v0
    v_lshl_add_u32 v11, v12, 4, v11
    v_add_u32 v217, s42, v11
S_nf2C:
    v_bfe_u32 v11, v0, 2, 2
    v_lshl_add_u32 v11, v242, 3, v11
    v_lshlrev_b32 v11, 5, v11
    v_and_b32 v12, 3, v0
    v_lshl_add_u32 v11, v12, 3, v11
    s_mul_i32 s42, s20, 2560
    s_add_u32 s42, s42, 102400
    v_add_u32 v222, s42, v11
    v_mov_b32 v160, v14
    v_mov_b32 v161, v14
    v_mov_b32 v162, v14
    v_mov_b32 v163, v14
    v_mov_b32 v164, v14
    v_mov_b32 v165, v14
    v_mov_b32 v166, v14
    v_mov_b32 v167, v14
    v_mov_b32 v168, v14
    v_mov_b32 v169, v14
    v_mov_b32 v170, v14
    v_mov_b32 v171, v14
    v_mov_b32 v172, v14
    v_mov_b32 v173, v14
    v_mov_b32 v174, v14
    v_mov_b32 v175, v14
    v_mov_b32 v176, 0
    v_mov_b32 v177, 0
    v_mov_b32 v178, 0
    v_mov_b32 v179, 0
    v_mov_b32 v180, 0
    v_mov_b32 v181, 0
    v_mov_b32 v182, 0
    v_mov_b32 v183, 0
    v_mov_b32 v184, 0
    v_mov_b32 v185, 0
    v_mov_b32 v186, 0
    v_mov_b32 v187, 0
    v_mov_b32 v188, 0
    v_mov_b32 v189, 0
    v_mov_b32 v190, 0
    v_mov_b32 v191, 0
    v_mov_b32 v192, 0
    v_mov_b32 v193, 0
    v_mov_b32 v194, 0
    v_mov_b32 v195, 0
    v_mov_b32 v196, 0
    v_mov_b32 v197, 0
    v_mov_b32 v198, 0
    v_mov_b32 v199, 0
    v_mov_b32 v200, 0
    v_mov_b32 v201, 0
    v_mov_b32 v202, 0
    v_mov_b32 v203, 0
    v_mov_b32 v204, 0
    v_mov_b32 v205, 0
    v_mov_b32 v206, 0
    v_mov_b32 v207, 0
    s_cmp_lt_u32 s20, 5
    s_cselect_b32 s42, 0x80000000, -1
    v_mov_b32 v232, s42
    v_mov_b32 v233, s42
    s_lshr_b32 s21, s32, 1
    s_and_b32 s22, s32, 1
    s_lshr_b32 s26, s20, 1
    s_and_b32 s27, s20, 1
    v_and_b32 v13, 15, v0
    v_lshrrev_b32 v14, 4, v0
    v_lshrrev_b32 v1, 1, v13
    v_xor_b32 v1, v1, v14
    v_lshlrev_b32 v1, 4, v1
    v_lshl_add_u32 v1, v13, 7, v1
    s_lshl_b32 s28, s26, 13
    v_add_u32 v2, s28, v1
    v_xor_b32 v3, 64, v2
    v_bfe_u32 v1, v0, 2, 2
    v_and_b32 v15, 1, v14
    v_lshl_add_u32 v15, v15, 2, v1
    s_lshl_b32 s28, s27, 2
    v_xor_b32 v15, s28, v15
    v_lshlrev_b32 v15, 5, v15
    v_lshl_add_u32 v1, v14, 3, v1
    v_lshl_add_u32 v15, v1, 8, v15
    v_and_b32 v1, 3, v0
    v_lshl_add_u32 v15, v1, 3, v15
    v_add_u32 v4, 16384, v15
    v_xor_b32 v5, 32, v4
    v_xor_b32 v6, 64, v4
    v_xor_b32 v7, 0x60, v4
    v_bfe_u32 v1, v0, 1, 1
    v_lshrrev_b32 v15, 5, v0
    v_cmp_eq_u32 vcc, v1, v15
    v_mov_b32 v8, 0x3f803f80
    v_and_b32 v1, 1, v0
    v_cndmask_b32 v8, 0, v8, vcc
    v_cmp_eq_u32 vcc, 0, v1
    v_mov_b32 v12, 0xeeee
    v_mov_b32 v15, 0x4444
    v_mov_b32 v9, v8
    v_mov_b32 v10, v8
    v_mov_b32 v11, v8
    v_cndmask_b32 v12, v12, v15, vcc
    v_mov_b32 v80, 0
    v_mov_b32 v81, 0
    v_mov_b32 v82, 0
    v_mov_b32 v83, 0
    v_mov_b32 v84, 0
    v_mov_b32 v85, 0
    v_mov_b32 v86, 0
    v_mov_b32 v87, 0
    v_mov_b32 v88, 0
    v_mov_b32 v89, 0
    v_mov_b32 v90, 0
    v_mov_b32 v91, 0
    v_mov_b32 v92, 0
    v_mov_b32 v93, 0
    v_mov_b32 v94, 0
    v_mov_b32 v95, 0
    v_mov_b32 v96, 0
    v_mov_b32 v97, 0
    v_mov_b32 v98, 0
    v_mov_b32 v99, 0
    v_mov_b32 v100, 0
    v_mov_b32 v101, 0
    v_mov_b32 v102, 0
    v_mov_b32 v103, 0
    v_mov_b32 v104, 0
    v_mov_b32 v105, 0
    v_mov_b32 v106, 0
    v_mov_b32 v107, 0
    v_mov_b32 v108, 0
    v_mov_b32 v109, 0
    v_mov_b32 v110, 0
    v_mov_b32 v111, 0
    v_mov_b32 v112, 0
    v_mov_b32 v113, 0
    v_mov_b32 v114, 0
    v_mov_b32 v115, 0
    v_mov_b32 v116, 0
    v_mov_b32 v117, 0
    v_mov_b32 v118, 0
    v_mov_b32 v119, 0
    v_mov_b32 v120, 0
    v_mov_b32 v121, 0
    v_mov_b32 v122, 0
    v_mov_b32 v123, 0
    v_mov_b32 v124, 0
    v_mov_b32 v125, 0
    v_mov_b32 v126, 0
    v_mov_b32 v127, 0
    v_mov_b32 v128, 0
    v_mov_b32 v129, 0
    v_mov_b32 v130, 0
    v_mov_b32 v131, 0
    v_mov_b32 v132, 0
    v_mov_b32 v133, 0
    v_mov_b32 v134, 0
    v_mov_b32 v135, 0
    v_mov_b32 v136, 0
    v_mov_b32 v137, 0
    v_mov_b32 v138, 0
    v_mov_b32 v139, 0
    v_mov_b32 v140, 0
    v_mov_b32 v141, 0
    v_mov_b32 v142, 0
    v_mov_b32 v143, 0
    v_mov_b32 v144, 0
    v_mov_b32 v145, 0
    v_mov_b32 v146, 0
    v_mov_b32 v147, 0
    v_mov_b32 v148, 0
    v_mov_b32 v149, 0
    v_mov_b32 v150, 0
    v_mov_b32 v151, 0
    v_mov_b32 v152, 0
    v_mov_b32 v153, 0
    v_mov_b32 v154, 0
    v_mov_b32 v155, 0
    v_mov_b32 v156, 0
    v_mov_b32 v157, 0
    v_mov_b32 v158, 0
    v_mov_b32 v159, 0
    s_mov_b32 s28, 131072
    v_lshl_add_u32 v250, v13, 2, s28
    v_lshl_add_u32 v251, v14, 4, s28
    s_lshl_b32 s35, s21, 2
    s_lshl_b32 s28, s26, 1
    s_add_u32 s35, s35, s28
    s_mul_i32 s40, s35, 2560
    s_mul_i32 s28, s33, 327680
    s_add_u32 s40, s40, s28
    s_mul_i32 s28, s22, 2621440
    s_add_u32 s40, s40, s28
    s_add_u32 s41, s40, 2560
    s_lshl_b32 s42, s33, 2
    s_lshl_b32 s28, s22, 1
    s_add_u32 s42, s42, s28
    s_mul_i32 s42, s42, 81920
    s_mul_i32 s28, s35, 1280
    s_add_u32 s42, s42, s28
    s_add_u32 s42, s42, 5242880
    v_and_b32 v1, 31, v0
    v_and_b32 v16, 3, v0
    v_bfe_u32 v17, v0, 2, 2
    v_lshl_add_u32 v16, v17, 3, v16
    v_bfe_u32 v17, v0, 4, 1
    v_lshl_add_u32 v16, v17, 2, v16
    s_cmp_eq_u32 s22, 0
    s_cselect_b64 vcc, -1, 0
    s_cselect_b32 s34, 0x3ea52b5c, 1.0
    v_cndmask_b32 v1, v16, v1, vcc
    v_lshrrev_b32 v16, 5, v0
    v_lshlrev_b32 v1, 4, v1
    v_lshl_add_u32 v246, v16, 9, v1
    v_mul_u32_u24 v16, 161280, v16
    v_add_u32 v247, v16, v246
    v_add_u32 v248, 161280, v246
    v_mov_b32 v249, 0
    s_cmp_eq_u32 s27, 0
    s_cbranch_scc1 A_ea
    v_add_u32 v246, 165376, v246
    v_mul_u32_u24 v16, 320, v14
    v_lshl_add_u32 v247, v13, 4, v16
    v_cmp_gt_u32 vcc, 4, v13
    v_add_u32 v16, 256, v247
    v_add_u32 v17, 81856, v247
    v_cndmask_b32 v248, v17, v16, vcc
    v_cmp_gt_u32 vcc, 8, v13
    v_add_u32 v16, 82112, v247
    v_mov_b32 v17, 0x7fffffff
    v_cndmask_b32 v249, v17, v16, vcc
A_ea:
    s_mov_b32 s35, 0x3acccccd
    s_mov_b32 s44, 0x22222222
    s_mov_b32 s45, s44
    s_mov_b32 s46, 0x44444444
    s_mov_b32 s47, s46
    s_mov_b32 s52, 0x88888888
    s_mov_b32 s53, s52
    s_mov_b32 s54, 0x00f0000f
    s_mov_b32 s55, 0xf0000f00
    s_mov_b32 s29, 0
    s_mov_b32 s30, 32768
    v_mov_b32 v1, 159904
    ds_write_b128 v1, v[80:83]
    s_or_b32 s28, s20, s32
    s_cbranch_scc1 A_nlead
    s_or_b32 s31, s3, 0x100
    v_mov_b32 v1, s31
    s_mov_b64 exec, 1
    s_waitcnt vmcnt(0)
    buffer_store_dword v1, off, s[12:15], s38 sc1
    s_mov_b64 exec, -1
A_nlead:
    s_barrier
    ds_read_b128 v[16:19], v2 offset:0
    ds_read_b64_tr_b16 v[32:33], v4 offset:0
    ds_read_b64_tr_b16 v[34:35], v4 offset:1024
    ds_read_b128 v[20:23], v2 offset:2048
    ds_read_b64_tr_b16 v[36:37], v5 offset:0
    ds_read_b64_tr_b16 v[38:39], v5 offset:1024
    ds_read_b128 v[24:27], v2 offset:4096
    ds_read_b64_tr_b16 v[40:41], v6 offset:0
    ds_read_b64_tr_b16 v[42:43], v6 offset:1024
    ds_read_b128 v[28:31], v2 offset:6144
    ds_read_b64_tr_b16 v[44:45], v7 offset:0
    ds_read_b64_tr_b16 v[46:47], v7 offset:1024
    s_cmp_eq_u32 s20, 1
    s_cbranch_scc1 A_loop1
    s_cmp_eq_u32 s20, 2
    s_cbranch_scc1 A_loop2
    s_cmp_eq_u32 s20, 3
    s_cbranch_scc1 A_loop3
    .p2align 3
A_loop0:
    s_waitcnt lgkmcnt(0)
    v_mfma_f32_16x16x32_bf16 v[80:83], v[32:35], v[16:19], v[80:83]
    ds_read_b128 v[48:51], v3 offset:0
    v_mfma_f32_16x16x32_bf16 v[84:87], v[32:35], v[20:23], v[84:87]
    ds_read_b64_tr_b16 v[64:65], v4 offset:8192
    v_mfma_f32_16x16x32_bf16 v[88:91], v[32:35], v[24:27], v[88:91]
    ds_read_b64_tr_b16 v[66:67], v4 offset:9216
    v_mfma_f32_16x16x32_bf16 v[92:95], v[32:35], v[28:31], v[92:95]
    ds_read_b128 v[52:55], v3 offset:2048
    v_mfma_f32_16x16x32_bf16 v[96:99], v[36:39], v[16:19], v[96:99]
    ds_read_b64_tr_b16 v[68:69], v5 offset:8192
    v_mfma_f32_16x16x32_bf16 v[100:103], v[36:39], v[20:23], v[100:103]
    ds_read_b64_tr_b16 v[70:71], v5 offset:9216
    v_mfma_f32_16x16x32_bf16 v[104:107], v[36:39], v[24:27], v[104:107]
    ds_read_b128 v[56:59], v3 offset:4096
    v_mfma_f32_16x16x32_bf16 v[108:111], v[36:39], v[28:31], v[108:111]
    ds_read_b64_tr_b16 v[72:73], v6 offset:8192
    v_mfma_f32_16x16x32_bf16 v[112:115], v[40:43], v[16:19], v[112:115]
    ds_read_b64_tr_b16 v[74:75], v6 offset:9216
    v_mfma_f32_16x16x32_bf16 v[116:119], v[40:43], v[20:23], v[116:119]
    ds_read_b128 v[60:63], v3 offset:6144
    v_mfma_f32_16x16x32_bf16 v[120:123], v[40:43], v[24:27], v[120:123]
    ds_read_b64_tr_b16 v[76:77], v7 offset:8192
    v_mfma_f32_16x16x32_bf16 v[124:127], v[40:43], v[28:31], v[124:127]
    ds_read_b64_tr_b16 v[78:79], v7 offset:9216
    v_mfma_f32_16x16x32_bf16 v[128:131], v[44:47], v[16:19], v[128:131]
    s_add_u32 s29, s29, 1
    v_mfma_f32_16x16x32_bf16 v[132:135], v[44:47], v[20:23], v[132:135]
    s_and_b32 s28, s29, 3
    s_cselect_b32 s28, s30, 4294868992
    v_mfma_f32_16x16x32_bf16 v[136:139], v[44:47], v[24:27], v[136:139]
    s_cmp_eq_u32 s29, 10
    v_mfma_f32_16x16x32_bf16 v[140:143], v[44:47], v[28:31], v[140:143]
    v_mfma_f32_16x16x32_bf16 v[144:147], v[16:19], v[16:19], v[144:147]
    v_mfma_f32_16x16x32_bf16 v[148:151], v[20:23], v[20:23], v[148:151]
    v_smfmac_f32_16x16x64_bf16 v[152:155], v[8:11], v[16:23], v12
    v_smfmac_f32_16x16x64_bf16 v[156:159], v[8:11], v[32:39], v12
    s_waitcnt lgkmcnt(0)
    s_cbranch_scc1 A_last0
    s_barrier
    s_cmp_eq_u32 s29, s39
    s_cbranch_scc1 A_ann
A_annd:
    v_mfma_f32_16x16x32_bf16 v[80:83], v[64:67], v[48:51], v[80:83]
    v_add_u32 v2, s28, v2
    v_add_u32 v4, s28, v4
    v_mfma_f32_16x16x32_bf16 v[84:87], v[64:67], v[52:55], v[84:87]
    ds_read_b128 v[16:19], v2 offset:0
    v_mfma_f32_16x16x32_bf16 v[88:91], v[64:67], v[56:59], v[88:91]
    ds_read_b64_tr_b16 v[32:33], v4 offset:0
    v_mfma_f32_16x16x32_bf16 v[92:95], v[64:67], v[60:63], v[92:95]
    ds_read_b64_tr_b16 v[34:35], v4 offset:1024
    v_add_u32 v5, s28, v5
    v_mfma_f32_16x16x32_bf16 v[96:99], v[68:71], v[48:51], v[96:99]
    ds_read_b128 v[20:23], v2 offset:2048
    v_mfma_f32_16x16x32_bf16 v[100:103], v[68:71], v[52:55], v[100:103]
    ds_read_b64_tr_b16 v[36:37], v5 offset:0
    v_mfma_f32_16x16x32_bf16 v[104:107], v[68:71], v[56:59], v[104:107]
    ds_read_b64_tr_b16 v[38:39], v5 offset:1024
    v_add_u32 v6, s28, v6
    v_mfma_f32_16x16x32_bf16 v[108:111], v[68:71], v[60:63], v[108:111]
    ds_read_b128 v[24:27], v2 offset:4096
    v_mfma_f32_16x16x32_bf16 v[112:115], v[72:75], v[48:51], v[112:115]
    ds_read_b64_tr_b16 v[40:41], v6 offset:0
    v_mfma_f32_16x16x32_bf16 v[116:119], v[72:75], v[52:55], v[116:119]
    ds_read_b64_tr_b16 v[42:43], v6 offset:1024
    v_add_u32 v7, s28, v7
    v_mfma_f32_16x16x32_bf16 v[120:123], v[72:75], v[56:59], v[120:123]
    ds_read_b128 v[28:31], v2 offset:6144
    v_mfma_f32_16x16x32_bf16 v[124:127], v[72:75], v[60:63], v[124:127]
    ds_read_b64_tr_b16 v[44:45], v7 offset:0
    v_mfma_f32_16x16x32_bf16 v[128:131], v[76:79], v[48:51], v[128:131]
    ds_read_b64_tr_b16 v[46:47], v7 offset:1024
    v_mfma_f32_16x16x32_bf16 v[132:135], v[76:79], v[52:55], v[132:135]
    v_add_u32 v3, s28, v3
    v_mfma_f32_16x16x32_bf16 v[136:139], v[76:79], v[56:59], v[136:139]
    v_mfma_f32_16x16x32_bf16 v[140:143], v[76:79], v[60:63], v[140:143]
    v_mfma_f32_16x16x32_bf16 v[144:147], v[48:51], v[48:51], v[144:147]
    v_mfma_f32_16x16x32_bf16 v[148:151], v[52:55], v[52:55], v[148:151]
    v_smfmac_f32_16x16x64_bf16 v[152:155], v[8:11], v[48:55], v12
    v_smfmac_f32_16x16x64_bf16 v[156:159], v[8:11], v[64:71], v12
    s_branch A_loop0
A_ann:
    s_cmp_eq_u32 s39, 4
    s_cbranch_scc1 A_ann2
    s_cmp_eq_u32 s39, 8
    s_cbranch_scc1 A_ann5
    buffer_load_dword v15, off, s[12:15], s38 sc1
    s_mov_b32 s39, 4
    s_branch A_annd
A_ann2:
    s_mov_b32 s39, 262144
A_ann3:
    s_waitcnt vmcnt(0)
    v_readfirstlane_b32 s31, v15
    s_cmp_lg_u32 s31, 0
    s_cbranch_scc1 A_ann4
    s_sub_u32 s39, s39, 1
    s_cbranch_scc1 A_ann4
    buffer_load_dword v15, off, s[12:15], s38 sc1
    s_branch A_ann3
A_ann4:
    s_and_b32 s31, s31, 0xff
    s_cmp_eq_u32 s31, s3
    s_cselect_b32 s31, 1, 2
    v_mov_b32 v1, s31
    s_mov_b64 exec, 1
    buffer_store_dword v1, off, s[16:19], s37 offset:1024 sc1
    s_mov_b64 exec, -1
    s_mov_b32 s39, 8
    s_branch A_annd
A_ann5:
    v_and_b32 v1, 31, v0
    v_lshlrev_b32 v1, 7, v1
    buffer_load_dword v15, v1, s[16:19], s36 offen offset:1024 sc1
    s_branch A_annd
A_dbg:
    s_sub_u32 s39, s39, 1
    s_cbranch_scc1 A_dbgd
    buffer_load_dword v15, v1, s[16:19], s36 offen offset:1024 sc1
    s_branch A_dbg0
A_last0:
    v_mfma_f32_16x16x32_bf16 v[144:147], v[48:51], v[48:51], v[144:147]
    v_mfma_f32_16x16x32_bf16 v[148:151], v[52:55], v[52:55], v[148:151]
    v_smfmac_f32_16x16x64_bf16 v[152:155], v[8:11], v[48:55], v12
    v_smfmac_f32_16x16x64_bf16 v[156:159], v[8:11], v[64:71], v12
    s_mov_b32 s39, 262144
A_dbg0:
    s_waitcnt vmcnt(0)
    v_cmp_eq_u32 vcc, 0, v15
    s_cbranch_vccnz A_dbg
A_dbgd:
    v_cmp_ne_u32 vcc, 1, v15
    v_mov_b32 v1, 159888
    s_cmp_eq_u64 vcc, 0
    s_cselect_b32 s28, 1, 0
    v_mov_b32 v15, s28
    ds_write_b32 v1, v15
    v_mfma_f32_16x16x32_bf16 v[80:83], v[64:67], v[48:51], v[80:83]
    v_mfma_f32_16x16x32_bf16 v[84:87], v[64:67], v[52:55], v[84:87]
    v_mfma_f32_16x16x32_bf16 v[88:91], v[64:67], v[56:59], v[88:91]
    v_mfma_f32_16x16x32_bf16 v[92:95], v[64:67], v[60:63], v[92:95]
    v_mfma_f32_16x16x32_bf16 v[96:99], v[68:71], v[48:51], v[96:99]
    v_mfma_f32_16x16x32_bf16 v[100:103], v[68:71], v[52:55], v[100:103]
    v_cndmask_b32 v144, v144, v145, s[44:45]
    v_cndmask_b32 v148, v148, v149, s[44:45]
    v_cndmask_b32 v144, v144, v146, s[46:47]
    v_cndmask_b32 v148, v148, v150, s[46:47]
    v_cndmask_b32 v144, v144, v147, s[52:53]
    v_cndmask_b32 v148, v148, v151, s[52:53]
    v_mfma_f32_16x16x32_bf16 v[104:107], v[68:71], v[56:59], v[104:107]
    v_add_f32 v152, v152, v153
    v_add_f32 v154, v154, v155
    v_mul_f32 v144, s35, v144
    v_mul_f32 v148, s35, v148
    v_mul_f32 v152, s35, v152
    v_mul_f32 v154, s35, v154
    v_mfma_f32_16x16x32_bf16 v[108:111], v[68:71], v[60:63], v[108:111]
    v_fma_f32 v144, -v152, v152, v144
    v_fma_f32 v148, -v154, v154, v148
    v_max_f32 v144, 0, v144
    v_max_f32 v148, 0, v148
    v_add_f32 v144, 0x3727c5ac, v144
    v_add_f32 v148, 0x3727c5ac, v148
    v_mfma_f32_16x16x32_bf16 v[112:115], v[72:75], v[48:51], v[112:115]
    v_rsq_f32 v144, v144
    v_rsq_f32 v148, v148
    v_add_f32 v156, v156, v157
    v_add_f32 v158, v158, v159
    v_mul_f32 v152, -v152, v144
    v_mul_f32 v154, -v154, v148
    v_mfma_f32_16x16x32_bf16 v[116:119], v[72:75], v[52:55], v[116:119]
    v_mul_f32 v146, s34, v144
    v_mul_f32 v150, s34, v148
    v_mul_f32 v147, s34, v152
    v_mul_f32 v151, s34, v154
    v_lshl_add_u32 v1, v13, 2, v250
    s_mov_b64 exec, s[54:55]
    ds_write_b64 v1, v[146:147] offset:1536
    ds_write_b64 v1, v[150:151] offset:1664
    ds_write_b32 v250, v156 offset:1024
    ds_write_b32 v250, v158 offset:1088
    ds_write2_b32 v250, v144, v148 offset0:0 offset1:16
    ds_write2_b32 v250, v152, v154 offset0:128 offset1:144
    s_mov_b64 exec, -1
    v_mfma_f32_16x16x32_bf16 v[120:123], v[72:75], v[56:59], v[120:123]
    v_mfma_f32_16x16x32_bf16 v[124:127], v[72:75], v[60:63], v[124:127]
    v_mov_b32 v12, 159888
    s_waitcnt lgkmcnt(0)
    s_barrier
    ds_read_b64 v[16:17], v1 offset:1536
    ds_read_b64 v[18:19], v1 offset:1664
    ds_read_b64 v[20:21], v1 offset:1792
    ds_read_b64 v[22:23], v1 offset:1920
    ds_read_b128 v[32:35], v251 offset:1024
    v_mfma_f32_16x16x32_bf16 v[128:131], v[76:79], v[48:51], v[128:131]
    ds_read_b128 v[36:39], v251 offset:1088
    v_mfma_f32_16x16x32_bf16 v[132:135], v[76:79], v[52:55], v[132:135]
    ds_read_b128 v[40:43], v251 offset:1152
    v_mfma_f32_16x16x32_bf16 v[136:139], v[76:79], v[56:59], v[136:139]
    ds_read_b128 v[44:47], v251 offset:1216
    v_mfma_f32_16x16x32_bf16 v[140:143], v[76:79], v[60:63], v[140:143]
    ds_read_b32 v12, v12
    s_branch A_epi0
    .p2align 3
A_loop1:
    s_waitcnt lgkmcnt(0)
    v_mfma_f32_16x16x32_bf16 v[80:83], v[32:35], v[16:19], v[80:83]
    ds_read_b128 v[48:51], v3 offset:0
    v_mfma_f32_16x16x32_bf16 v[84:87], v[32:35], v[20:23], v[84:87]
    ds_read_b64_tr_b16 v[64:65], v4 offset:8192
    v_mfma_f32_16x16x32_bf16 v[88:91], v[32:35], v[24:27], v[88:91]
    ds_read_b64_tr_b16 v[66:67], v4 offset:9216
    v_mfma_f32_16x16x32_bf16 v[92:95], v[32:35], v[28:31], v[92:95]
    ds_read_b128 v[52:55], v3 offset:2048
    v_mfma_f32_16x16x32_bf16 v[96:99], v[16:19], v[36:39], v[96:99]
    ds_read_b64_tr_b16 v[68:69], v5 offset:8192
    v_mfma_f32_16x16x32_bf16 v[100:103], v[20:23], v[36:39], v[100:103]
    ds_read_b64_tr_b16 v[70:71], v5 offset:9216
    v_mfma_f32_16x16x32_bf16 v[104:107], v[24:27], v[36:39], v[104:107]
    ds_read_b128 v[56:59], v3 offset:4096
    v_mfma_f32_16x16x32_bf16 v[108:111], v[28:31], v[36:39], v[108:111]
    ds_read_b64_tr_b16 v[72:73], v6 offset:8192
    v_mfma_f32_16x16x32_bf16 v[112:115], v[16:19], v[40:43], v[112:115]
    ds_read_b64_tr_b16 v[74:75], v6 offset:9216
    v_mfma_f32_16x16x32_bf16 v[116:119], v[20:23], v[40:43], v[116:119]
    ds_read_b128 v[60:63], v3 offset:6144
    v_mfma_f32_16x16x32_bf16 v[120:123], v[24:27], v[40:43], v[120:123]
    ds_read_b64_tr_b16 v[76:77], v7 offset:8192
    v_mfma_f32_16x16x32_bf16 v[124:127], v[28:31], v[40:43], v[124:127]
    ds_read_b64_tr_b16 v[78:79], v7 offset:9216
    v_mfma_f32_16x16x32_bf16 v[128:131], v[16:19], v[44:47], v[128:131]
    s_add_u32 s29, s29, 1
    v_mfma_f32_16x16x32_bf16 v[132:135], v[20:23], v[44:47], v[132:135]
    s_and_b32 s28, s29, 3
    s_cselect_b32 s28, s30, 4294868992
    v_mfma_f32_16x16x32_bf16 v[136:139], v[24:27], v[44:47], v[136:139]
    s_cmp_eq_u32 s29, 10
    v_mfma_f32_16x16x32_bf16 v[140:143], v[28:31], v[44:47], v[140:143]
    v_mfma_f32_16x16x32_bf16 v[144:147], v[24:27], v[24:27], v[144:147]
    v_mfma_f32_16x16x32_bf16 v[148:151], v[28:31], v[28:31], v[148:151]
    v_smfmac_f32_16x16x64_bf16 v[152:155], v[8:11], v[24:31], v12
    v_smfmac_f32_16x16x64_bf16 v[156:159], v[8:11], v[32:39], v12
    s_waitcnt lgkmcnt(0)
    s_cbranch_scc1 A_last1
    s_barrier
    v_mfma_f32_16x16x32_bf16 v[80:83], v[64:67], v[48:51], v[80:83]
    v_add_u32 v2, s28, v2
    v_add_u32 v4, s28, v4
    v_mfma_f32_16x16x32_bf16 v[84:87], v[64:67], v[52:55], v[84:87]
    ds_read_b128 v[16:19], v2 offset:0
    v_mfma_f32_16x16x32_bf16 v[88:91], v[64:67], v[56:59], v[88:91]
    ds_read_b64_tr_b16 v[32:33], v4 offset:0
    v_mfma_f32_16x16x32_bf16 v[92:95], v[64:67], v[60:63], v[92:95]
    ds_read_b64_tr_b16 v[34:35], v4 offset:1024
    v_add_u32 v5, s28, v5
    v_mfma_f32_16x16x32_bf16 v[96:99], v[48:51], v[68:71], v[96:99]
    ds_read_b128 v[20:23], v2 offset:2048
    v_mfma_f32_16x16x32_bf16 v[100:103], v[52:55], v[68:71], v[100:103]
    ds_read_b64_tr_b16 v[36:37], v5 offset:0
    v_mfma_f32_16x16x32_bf16 v[104:107], v[56:59], v[68:71], v[104:107]
    ds_read_b64_tr_b16 v[38:39], v5 offset:1024
    v_add_u32 v6, s28, v6
    v_mfma_f32_16x16x32_bf16 v[108:111], v[60:63], v[68:71], v[108:111]
    ds_read_b128 v[24:27], v2 offset:4096
    v_mfma_f32_16x16x32_bf16 v[112:115], v[48:51], v[72:75], v[112:115]
    ds_read_b64_tr_b16 v[40:41], v6 offset:0
    v_mfma_f32_16x16x32_bf16 v[116:119], v[52:55], v[72:75], v[116:119]
    ds_read_b64_tr_b16 v[42:43], v6 offset:1024
    v_add_u32 v7, s28, v7
    v_mfma_f32_16x16x32_bf16 v[120:123], v[56:59], v[72:75], v[120:123]
    ds_read_b128 v[28:31], v2 offset:6144
    v_mfma_f32_16x16x32_bf16 v[124:127], v[60:63], v[72:75], v[124:127]
    ds_read_b64_tr_b16 v[44:45], v7 offset:0
    v_mfma_f32_16x16x32_bf16 v[128:131], v[48:51], v[76:79], v[128:131]
    ds_read_b64_tr_b16 v[46:47], v7 offset:1024
    v_mfma_f32_16x16x32_bf16 v[132:135], v[52:55], v[76:79], v[132:135]
    v_add_u32 v3, s28, v3
    v_mfma_f32_16x16x32_bf16 v[136:139], v[56:59], v[76:79], v[136:139]
    v_mfma_f32_16x16x32_bf16 v[140:143], v[60:63], v[76:79], v[140:143]
    v_mfma_f32_16x16x32_bf16 v[144:147], v[56:59], v[56:59], v[144:147]
    v_mfma_f32_16x16x32_bf16 v[148:151], v[60:63], v[60:63], v[148:151]
    v_smfmac_f32_16x16x64_bf16 v[152:155], v[8:11], v[56:63], v12
    v_smfmac_f32_16x16x64_bf16 v[156:159], v[8:11], v[64:71], v12
    s_branch A_loop1
A_last1:
    v_mfma_f32_16x16x32_bf16 v[144:147], v[56:59], v[56:59], v[144:147]
    v_mfma_f32_16x16x32_bf16 v[148:151], v[60:63], v[60:63], v[148:151]
    v_smfmac_f32_16x16x64_bf16 v[152:155], v[8:11], v[56:63], v12
    v_smfmac_f32_16x16x64_bf16 v[156:159], v[8:11], v[64:71], v12
    v_mfma_f32_16x16x32_bf16 v[80:83], v[64:67], v[48:51], v[80:83]
    v_mfma_f32_16x16x32_bf16 v[84:87], v[64:67], v[52:55], v[84:87]
    v_mfma_f32_16x16x32_bf16 v[88:91], v[64:67], v[56:59], v[88:91]
    v_mfma_f32_16x16x32_bf16 v[92:95], v[64:67], v[60:63], v[92:95]
    v_mfma_f32_16x16x32_bf16 v[96:99], v[48:51], v[68:71], v[96:99]
    v_mfma_f32_16x16x32_bf16 v[100:103], v[52:55], v[68:71], v[100:103]
    v_cndmask_b32 v144, v144, v145, s[44:45]
    v_cndmask_b32 v148, v148, v149, s[44:45]
    v_cndmask_b32 v144, v144, v146, s[46:47]
    v_cndmask_b32 v148, v148, v150, s[46:47]
    v_cndmask_b32 v144, v144, v147, s[52:53]
    v_cndmask_b32 v148, v148, v151, s[52:53]
    v_mfma_f32_16x16x32_bf16 v[104:107], v[56:59], v[68:71], v[104:107]
    v_add_f32 v152, v152, v153
    v_add_f32 v154, v154, v155
    v_mul_f32 v144, s35, v144
    v_mul_f32 v148, s35, v148
    v_mul_f32 v152, s35, v152
    v_mul_f32 v154, s35, v154
    v_mfma_f32_16x16x32_bf16 v[108:111], v[60:63], v[68:71], v[108:111]
    v_fma_f32 v144, -v152, v152, v144
    v_fma_f32 v148, -v154, v154, v148
    v_max_f32 v144, 0, v144
    v_max_f32 v148, 0, v148
    v_add_f32 v144, 0x3727c5ac, v144
    v_add_f32 v148, 0x3727c5ac, v148
    v_mfma_f32_16x16x32_bf16 v[112:115], v[48:51], v[72:75], v[112:115]
    v_rsq_f32 v144, v144
    v_rsq_f32 v148, v148
    v_add_f32 v156, v156, v157
    v_add_f32 v158, v158, v159
    v_mul_f32 v152, -v152, v144
    v_mul_f32 v154, -v154, v148
    v_mfma_f32_16x16x32_bf16 v[116:119], v[52:55], v[72:75], v[116:119]
    v_mul_f32 v146, s34, v144
    v_mul_f32 v150, s34, v148
    v_mul_f32 v147, s34, v152
    v_mul_f32 v151, s34, v154
    v_lshl_add_u32 v1, v13, 2, v250
    s_mov_b64 exec, s[54:55]
    ds_write_b64 v1, v[146:147] offset:1792
    ds_write_b64 v1, v[150:151] offset:1920
    ds_write_b32 v250, v156 offset:1280
    ds_write_b32 v250, v158 offset:1344
    ds_write2_b32 v250, v144, v148 offset0:32 offset1:48
    ds_write2_b32 v250, v152, v154 offset0:160 offset1:176
    s_mov_b64 exec, -1
    v_mfma_f32_16x16x32_bf16 v[120:123], v[56:59], v[72:75], v[120:123]
    v_mfma_f32_16x16x32_bf16 v[124:127], v[60:63], v[72:75], v[124:127]
    v_mov_b32 v12, 159888
    s_waitcnt lgkmcnt(0)
    s_barrier
    ds_read_b64 v[16:17], v1 offset:1536
    ds_read_b64 v[18:19], v1 offset:1664
    ds_read_b64 v[20:21], v1 offset:1792
    ds_read_b64 v[22:23], v1 offset:1920
    ds_read_b128 v[32:35], v251 offset:1280
    v_mfma_f32_16x16x32_bf16 v[128:131], v[48:51], v[76:79], v[128:131]
    ds_read_b32 v36, v250 offset:1344
    v_mfma_f32_16x16x32_bf16 v[132:135], v[52:55], v[76:79], v[132:135]
    ds_read_b32 v38, v250 offset:1408
    v_mfma_f32_16x16x32_bf16 v[136:139], v[56:59], v[76:79], v[136:139]
    ds_read_b32 v40, v250 offset:1472
    v_mfma_f32_16x16x32_bf16 v[140:143], v[60:63], v[76:79], v[140:143]
    ds_read_b32 v12, v12
    ds_read_b128 v[48:51], v251 offset:0
    ds_read_b128 v[64:67], v251 offset:512
    ds_read_b128 v[52:55], v251 offset:64
    ds_read_b128 v[68:71], v251 offset:576
    ds_read_b128 v[56:59], v251 offset:128
    ds_read_b128 v[72:75], v251 offset:640
    ds_read_b128 v[60:63], v251 offset:192
    ds_read_b128 v[76:79], v251 offset:704
    s_branch A_epi1
    .p2align 3
A_loop2:
    s_waitcnt lgkmcnt(0)
    v_mfma_f32_16x16x32_bf16 v[80:83], v[32:35], v[16:19], v[80:83]
    ds_read_b128 v[48:51], v3 offset:0
    v_mfma_f32_16x16x32_bf16 v[84:87], v[32:35], v[20:23], v[84:87]
    ds_read_b64_tr_b16 v[64:65], v4 offset:8192
    v_mfma_f32_16x16x32_bf16 v[88:91], v[32:35], v[24:27], v[88:91]
    ds_read_b64_tr_b16 v[66:67], v4 offset:9216
    v_mfma_f32_16x16x32_bf16 v[92:95], v[32:35], v[28:31], v[92:95]
    ds_read_b128 v[52:55], v3 offset:2048
    v_mfma_f32_16x16x32_bf16 v[96:99], v[36:39], v[16:19], v[96:99]
    ds_read_b64_tr_b16 v[68:69], v5 offset:8192
    v_mfma_f32_16x16x32_bf16 v[100:103], v[36:39], v[20:23], v[100:103]
    ds_read_b64_tr_b16 v[70:71], v5 offset:9216
    v_mfma_f32_16x16x32_bf16 v[104:107], v[36:39], v[24:27], v[104:107]
    ds_read_b128 v[56:59], v3 offset:4096
    v_mfma_f32_16x16x32_bf16 v[108:111], v[36:39], v[28:31], v[108:111]
    ds_read_b64_tr_b16 v[72:73], v6 offset:8192
    v_mfma_f32_16x16x32_bf16 v[112:115], v[40:43], v[16:19], v[112:115]
    ds_read_b64_tr_b16 v[74:75], v6 offset:9216
    v_mfma_f32_16x16x32_bf16 v[116:119], v[40:43], v[20:23], v[116:119]
    ds_read_b128 v[60:63], v3 offset:6144
    v_mfma_f32_16x16x32_bf16 v[120:123], v[40:43], v[24:27], v[120:123]
    ds_read_b64_tr_b16 v[76:77], v7 offset:8192
    v_mfma_f32_16x16x32_bf16 v[124:127], v[40:43], v[28:31], v[124:127]
    ds_read_b64_tr_b16 v[78:79], v7 offset:9216
    v_mfma_f32_16x16x32_bf16 v[128:131], v[44:47], v[16:19], v[128:131]
    s_add_u32 s29, s29, 1
    v_mfma_f32_16x16x32_bf16 v[132:135], v[44:47], v[20:23], v[132:135]
    s_and_b32 s28, s29, 3
    s_cselect_b32 s28, s30, 4294868992
    v_mfma_f32_16x16x32_bf16 v[136:139], v[44:47], v[24:27], v[136:139]
    s_cmp_eq_u32 s29, 10
    v_mfma_f32_16x16x32_bf16 v[140:143], v[44:47], v[28:31], v[140:143]
    v_mfma_f32_16x16x32_bf16 v[144:147], v[16:19], v[16:19], v[144:147]
    v_mfma_f32_16x16x32_bf16 v[148:151], v[20:23], v[20:23], v[148:151]
    v_smfmac_f32_16x16x64_bf16 v[152:155], v[8:11], v[16:23], v12
    v_smfmac_f32_16x16x64_bf16 v[156:159], v[8:11], v[40:47], v12
    s_waitcnt lgkmcnt(0)
    s_cbranch_scc1 A_last2
    s_barrier
    v_mfma_f32_16x16x32_bf16 v[80:83], v[64:67], v[48:51], v[80:83]
    v_add_u32 v2, s28, v2
    v_add_u32 v4, s28, v4
    v_mfma_f32_16x16x32_bf16 v[84:87], v[64:67], v[52:55], v[84:87]
    ds_read_b128 v[16:19], v2 offset:0
    v_mfma_f32_16x16x32_bf16 v[88:91], v[64:67], v[56:59], v[88:91]
    ds_read_b64_tr_b16 v[32:33], v4 offset:0
    v_mfma_f32_16x16x32_bf16 v[92:95], v[64:67], v[60:63], v[92:95]
    ds_read_b64_tr_b16 v[34:35], v4 offset:1024
    v_add_u32 v5, s28, v5
    v_mfma_f32_16x16x32_bf16 v[96:99], v[68:71], v[48:51], v[96:99]
    ds_read_b128 v[20:23], v2 offset:2048
    v_mfma_f32_16x16x32_bf16 v[100:103], v[68:71], v[52:55], v[100:103]
    ds_read_b64_tr_b16 v[36:37], v5 offset:0
    v_mfma_f32_16x16x32_bf16 v[104:107], v[68:71], v[56:59], v[104:107]
    ds_read_b64_tr_b16 v[38:39], v5 offset:1024
    v_add_u32 v6, s28, v6
    v_mfma_f32_16x16x32_bf16 v[108:111], v[68:71], v[60:63], v[108:111]
    ds_read_b128 v[24:27], v2 offset:4096
    v_mfma_f32_16x16x32_bf16 v[112:115], v[72:75], v[48:51], v[112:115]
    ds_read_b64_tr_b16 v[40:41], v6 offset:0
    v_mfma_f32_16x16x32_bf16 v[116:119], v[72:75], v[52:55], v[116:119]
    ds_read_b64_tr_b16 v[42:43], v6 offset:1024
    v_add_u32 v7, s28, v7
    v_mfma_f32_16x16x32_bf16 v[120:123], v[72:75], v[56:59], v[120:123]
    ds_read_b128 v[28:31], v2 offset:6144
    v_mfma_f32_16x16x32_bf16 v[124:127], v[72:75], v[60:63], v[124:127]
    ds_read_b64_tr_b16 v[44:45], v7 offset:0
    v_mfma_f32_16x16x32_bf16 v[128:131], v[76:79], v[48:51], v[128:131]
    ds_read_b64_tr_b16 v[46:47], v7 offset:1024
    v_mfma_f32_16x16x32_bf16 v[132:135], v[76:79], v[52:55], v[132:135]
    v_add_u32 v3, s28, v3
    v_mfma_f32_16x16x32_bf16 v[136:139], v[76:79], v[56:59], v[136:139]
    v_mfma_f32_16x16x32_bf16 v[140:143], v[76:79], v[60:63], v[140:143]
    v_mfma_f32_16x16x32_bf16 v[144:147], v[48:51], v[48:51], v[144:147]
    v_mfma_f32_16x16x32_bf16 v[148:151], v[52:55], v[52:55], v[148:151]
    v_smfmac_f32_16x16x64_bf16 v[152:155], v[8:11], v[48:55], v12
    v_smfmac_f32_16x16x64_bf16 v[156:159], v[8:11], v[72:79], v12
    s_branch A_loop2
A_last2:
    v_mfma_f32_16x16x32_bf16 v[144:147], v[48:51], v[48:51], v[144:147]
    v_mfma_f32_16x16x32_bf16 v[148:151], v[52:55], v[52:55], v[148:151]
    v_smfmac_f32_16x16x64_bf16 v[152:155], v[8:11], v[48:55], v12
    v_smfmac_f32_16x16x64_bf16 v[156:159], v[8:11], v[72:79], v12
    v_mfma_f32_16x16x32_bf16 v[80:83], v[64:67], v[48:51], v[80:83]
    v_mfma_f32_16x16x32_bf16 v[84:87], v[64:67], v[52:55], v[84:87]
    v_mfma_f32_16x16x32_bf16 v[88:91], v[64:67], v[56:59], v[88:91]
    v_mfma_f32_16x16x32_bf16 v[92:95], v[64:67], v[60:63], v[92:95]
    v_mfma_f32_16x16x32_bf16 v[96:99], v[68:71], v[48:51], v[96:99]
    v_mfma_f32_16x16x32_bf16 v[100:103], v[68:71], v[52:55], v[100:103]
    v_cndmask_b32 v144, v144, v145, s[44:45]
    v_cndmask_b32 v148, v148, v149, s[44:45]
    v_cndmask_b32 v144, v144, v146, s[46:47]
    v_cndmask_b32 v148, v148, v150, s[46:47]
    v_cndmask_b32 v144, v144, v147, s[52:53]
    v_cndmask_b32 v148, v148, v151, s[52:53]
    v_mfma_f32_16x16x32_bf16 v[104:107], v[68:71], v[56:59], v[104:107]
    v_add_f32 v152, v152, v153
    v_add_f32 v154, v154, v155
    v_mul_f32 v144, s35, v144
    v_mul_f32 v148, s35, v148
    v_mul_f32 v152, s35, v152
    v_mul_f32 v154, s35, v154
    v_mfma_f32_16x16x32_bf16 v[108:111], v[68:71], v[60:63], v[108:111]
    v_fma_f32 v144, -v152, v152, v144
    v_fma_f32 v148, -v154, v154, v148
    v_max_f32 v144, 0, v144
    v_max_f32 v148, 0, v148
    v_add_f32 v144, 0x3727c5ac, v144
    v_add_f32 v148, 0x3727c5ac, v148
    v_mfma_f32_16x16x32_bf16 v[112:115], v[72:75], v[48:51], v[112:115]
    v_rsq_f32 v144, v144
    v_rsq_f32 v148, v148
    v_add_f32 v156, v156, v157
    v_add_f32 v158, v158, v159
    v_mul_f32 v152, -v152, v144
    v_mul_f32 v154, -v154, v148
    v_mfma_f32_16x16x32_bf16 v[116:119], v[72:75], v[52:55], v[116:119]
    v_mul_f32 v146, s34, v144
    v_mul_f32 v150, s34, v148
    v_mul_f32 v147, s34, v152
    v_mul_f32 v151, s34, v154
    v_lshl_add_u32 v1, v13, 2, v250
    s_mov_b64 exec, s[54:55]
    ds_write_b64 v1, v[146:147] offset:2048
    ds_write_b64 v1, v[150:151] offset:2176
    ds_write_b32 v250, v156 offset:1152
    ds_write_b32 v250, v158 offset:1216
    ds_write2_b32 v250, v144, v148 offset0:64 offset1:80
    ds_write2_b32 v250, v152, v154 offset0:192 offset1:208
    s_mov_b64 exec, -1
    v_mfma_f32_16x16x32_bf16 v[120:123], v[72:75], v[56:59], v[120:123]
    v_mfma_f32_16x16x32_bf16 v[124:127], v[72:75], v[60:63], v[124:127]
    v_mov_b32 v12, 159888
    s_waitcnt lgkmcnt(0)
    s_barrier
    ds_read_b64 v[16:17], v1 offset:2048
    ds_read_b64 v[18:19], v1 offset:2176
    ds_read_b64 v[20:21], v1 offset:2304
    ds_read_b64 v[22:23], v1 offset:2432
    ds_read_b128 v[32:35], v251 offset:1024
    v_mfma_f32_16x16x32_bf16 v[128:131], v[76:79], v[48:51], v[128:131]
    ds_read_b128 v[36:39], v251 offset:1088
    v_mfma_f32_16x16x32_bf16 v[132:135], v[76:79], v[52:55], v[132:135]
    ds_read_b128 v[40:43], v251 offset:1152
    v_mfma_f32_16x16x32_bf16 v[136:139], v[76:79], v[56:59], v[136:139]
    ds_read_b128 v[44:47], v251 offset:1216
    v_mfma_f32_16x16x32_bf16 v[140:143], v[76:79], v[60:63], v[140:143]
    ds_read_b32 v12, v12
A_epi0:
    s_waitcnt lgkmcnt(0)
    v_pk_mul_f32 v[80:81], v[80:81], v[16:17] op_sel_hi:[1,0]
    v_pk_mul_f32 v[82:83], v[82:83], v[16:17] op_sel_hi:[1,0]
    v_pk_mul_f32 v[84:85], v[84:85], v[18:19] op_sel_hi:[1,0]
    v_pk_mul_f32 v[86:87], v[86:87], v[18:19] op_sel_hi:[1,0]
    v_pk_fma_f32 v[80:81], v[32:33], v[16:17], v[80:81] op_sel:[0,1,0]
    v_pk_fma_f32 v[82:83], v[34:35], v[16:17], v[82:83] op_sel:[0,1,0]
    v_pk_fma_f32 v[84:85], v[32:33], v[18:19], v[84:85] op_sel:[0,1,0]
    v_pk_fma_f32 v[86:87], v[34:35], v[18:19], v[86:87] op_sel:[0,1,0]
    v_cvt_pk_bf16_f32 v80, v80, v81
    v_cvt_pk_bf16_f32 v81, v82, v83
    v_cvt_pk_bf16_f32 v82, v84, v85
    v_cvt_pk_bf16_f32 v83, v86, v87
    v_pk_mul_f32 v[88:89], v[88:89], v[20:21] op_sel_hi:[1,0]
    v_pk_mul_f32 v[90:91], v[90:91], v[20:21] op_sel_hi:[1,0]
    v_permlane16_swap_b32 v80, v82
    v_permlane16_swap_b32 v81, v83
    buffer_store_dwordx4 v[80:83], v246, s[16:19], s40 offen offset:0
    v_pk_mul_f32 v[92:93], v[92:93], v[22:23] op_sel_hi:[1,0]
    v_pk_mul_f32 v[94:95], v[94:95], v[22:23] op_sel_hi:[1,0]
    v_pk_fma_f32 v[88:89], v[32:33], v[20:21], v[88:89] op_sel:[0,1,0]
    v_pk_fma_f32 v[90:91], v[34:35], v[20:21], v[90:91] op_sel:[0,1,0]
    v_pk_fma_f32 v[92:93], v[32:33], v[22:23], v[92:93] op_sel:[0,1,0]
    v_pk_fma_f32 v[94:95], v[34:35], v[22:23], v[94:95] op_sel:[0,1,0]
    v_cvt_pk_bf16_f32 v88, v88, v89
    v_cvt_pk_bf16_f32 v89, v90, v91
    v_cvt_pk_bf16_f32 v90, v92, v93
    v_cvt_pk_bf16_f32 v91, v94, v95
    v_pk_mul_f32 v[96:97], v[96:97], v[16:17] op_sel_hi:[1,0]
    v_pk_mul_f32 v[98:99], v[98:99], v[16:17] op_sel_hi:[1,0]
    v_permlane16_swap_b32 v88, v90
    v_permlane16_swap_b32 v89, v91
    buffer_store_dwordx4 v[88:91], v246, s[16:19], s41 offen offset:0
    v_pk_mul_f32 v[100:101], v[100:101], v[18:19] op_sel_hi:[1,0]
    v_pk_mul_f32 v[102:103], v[102:103], v[18:19] op_sel_hi:[1,0]
    v_pk_fma_f32 v[96:97], v[36:37], v[16:17], v[96:97] op_sel:[0,1,0]
    v_pk_fma_f32 v[98:99], v[38:39], v[16:17], v[98:99] op_sel:[0,1,0]
    v_pk_fma_f32 v[100:101], v[36:37], v[18:19], v[100:101] op_sel:[0,1,0]
    v_pk_fma_f32 v[102:103], v[38:39], v[18:19], v[102:103] op_sel:[0,1,0]
    v_cvt_pk_bf16_f32 v96, v96, v97
    v_cvt_pk_bf16_f32 v97, v98, v99
    v_cvt_pk_bf16_f32 v98, v100, v101
    v_cvt_pk_bf16_f32 v99, v102, v103
    v_pk_mul_f32 v[104:105], v[104:105], v[20:21] op_sel_hi:[1,0]
    v_pk_mul_f32 v[106:107], v[106:107], v[20:21] op_sel_hi:[1,0]
    v_permlane16_swap_b32 v96, v98
    v_permlane16_swap_b32 v97, v99
    buffer_store_dwordx4 v[96:99], v246, s[16:19], s40 offen offset:1024
    v_pk_mul_f32 v[108:109], v[108:109], v[22:23] op_sel_hi:[1,0]
    v_pk_mul_f32 v[110:111], v[110:111], v[22:23] op_sel_hi:[1,0]
    v_pk_fma_f32 v[104:105], v[36:37], v[20:21], v[104:105] op_sel:[0,1,0]
    v_pk_fma_f32 v[106:107], v[38:39], v[20:21], v[106:107] op_sel:[0,1,0]
    v_pk_fma_f32 v[108:109], v[36:37], v[22:23], v[108:109] op_sel:[0,1,0]
    v_pk_fma_f32 v[110:111], v[38:39], v[22:23], v[110:111] op_sel:[0,1,0]
    v_cvt_pk_bf16_f32 v104, v104, v105
    v_cvt_pk_bf16_f32 v105, v106, v107
    v_cvt_pk_bf16_f32 v106, v108, v109
    v_cvt_pk_bf16_f32 v107, v110, v111
    v_pk_mul_f32 v[112:113], v[112:113], v[16:17] op_sel_hi:[1,0]
    v_pk_mul_f32 v[114:115], v[114:115], v[16:17] op_sel_hi:[1,0]
    v_permlane16_swap_b32 v104, v106
    v_permlane16_swap_b32 v105, v107
    buffer_store_dwordx4 v[104:107], v246, s[16:19], s41 offen offset:1024
    v_pk_mul_f32 v[116:117], v[116:117], v[18:19] op_sel_hi:[1,0]
    v_pk_mul_f32 v[118:119], v[118:119], v[18:19] op_sel_hi:[1,0]
    v_pk_fma_f32 v[112:113], v[40:41], v[16:17], v[112:113] op_sel:[0,1,0]
    v_pk_fma_f32 v[114:115], v[42:43], v[16:17], v[114:115] op_sel:[0,1,0]
    v_pk_fma_f32 v[116:117], v[40:41], v[18:19], v[116:117] op_sel:[0,1,0]
    v_pk_fma_f32 v[118:119], v[42:43], v[18:19], v[118:119] op_sel:[0,1,0]
    v_cvt_pk_bf16_f32 v112, v112, v113
    v_cvt_pk_bf16_f32 v113, v114, v115
    v_cvt_pk_bf16_f32 v114, v116, v117
    v_cvt_pk_bf16_f32 v115, v118, v119
    v_pk_mul_f32 v[120:121], v[120:121], v[20:21] op_sel_hi:[1,0]
    v_pk_mul_f32 v[122:123], v[122:123], v[20:21] op_sel_hi:[1,0]
    v_permlane16_swap_b32 v112, v114
    v_permlane16_swap_b32 v113, v115
    buffer_store_dwordx4 v[112:115], v247, s[16:19], s40 offen offset:2048
    v_pk_mul_f32 v[124:125], v[124:125], v[22:23] op_sel_hi:[1,0]
    v_pk_mul_f32 v[126:127], v[126:127], v[22:23] op_sel_hi:[1,0]
    v_pk_fma_f32 v[120:121], v[40:41], v[20:21], v[120:121] op_sel:[0,1,0]
    v_pk_fma_f32 v[122:123], v[42:43], v[20:21], v[122:123] op_sel:[0,1,0]
    v_pk_fma_f32 v[124:125], v[40:41], v[22:23], v[124:125] op_sel:[0,1,0]
    v_pk_fma_f32 v[126:127], v[42:43], v[22:23], v[126:127] op_sel:[0,1,0]
    v_cvt_pk_bf16_f32 v120, v120, v121
    v_cvt_pk_bf16_f32 v121, v122, v123
    v_cvt_pk_bf16_f32 v122, v124, v125
    v_cvt_pk_bf16_f32 v123, v126, v127
    v_pk_mul_f32 v[128:129], v[128:129], v[16:17] op_sel_hi:[1,0]
    v_pk_mul_f32 v[130:131], v[130:131], v[16:17] op_sel_hi:[1,0]
    v_permlane16_swap_b32 v120, v122
    v_permlane16_swap_b32 v121, v123
    buffer_store_dwordx4 v[120:123], v247, s[16:19], s41 offen offset:2048
    v_pk_mul_f32 v[132:133], v[132:133], v[18:19] op_sel_hi:[1,0]
    v_pk_mul_f32 v[134:135], v[134:135], v[18:19] op_sel_hi:[1,0]
    v_pk_fma_f32 v[128:129], v[44:45], v[16:17], v[128:129] op_sel:[0,1,0]
    v_pk_fma_f32 v[130:131], v[46:47], v[16:17], v[130:131] op_sel:[0,1,0]
    v_pk_fma_f32 v[132:133], v[44:45], v[18:19], v[132:133] op_sel:[0,1,0]
    v_pk_fma_f32 v[134:135], v[46:47], v[18:19], v[134:135] op_sel:[0,1,0]
    v_cvt_pk_bf16_f32 v128, v128, v129
    v_cvt_pk_bf16_f32 v129, v130, v131
    v_cvt_pk_bf16_f32 v130, v132, v133
    v_cvt_pk_bf16_f32 v131, v134, v135
    v_pk_mul_f32 v[136:137], v[136:137], v[20:21] op_sel_hi:[1,0]
    v_pk_mul_f32 v[138:139], v[138:139], v[20:21] op_sel_hi:[1,0]
    v_permlane16_swap_b32 v128, v130
    v_permlane16_swap_b32 v129, v131
    buffer_store_dwordx4 v[128:131], v248, s[16:19], s40 offen offset:3072
    v_pk_mul_f32 v[140:141], v[140:141], v[22:23] op_sel_hi:[1,0]
    v_pk_mul_f32 v[142:143], v[142:143], v[22:23] op_sel_hi:[1,0]
    v_pk_fma_f32 v[136:137], v[44:45], v[20:21], v[136:137] op_sel:[0,1,0]
    v_pk_fma_f32 v[138:139], v[46:47], v[20:21], v[138:139] op_sel:[0,1,0]
    v_pk_fma_f32 v[140:141], v[44:45], v[22:23], v[140:141] op_sel:[0,1,0]
    v_pk_fma_f32 v[142:143], v[46:47], v[22:23], v[142:143] op_sel:[0,1,0]
    v_cvt_pk_bf16_f32 v136, v136, v137
    v_cvt_pk_bf16_f32 v137, v138, v139
    v_cvt_pk_bf16_f32 v138, v140, v141
    v_cvt_pk_bf16_f32 v139, v142, v143
    s_nop 0
    v_permlane16_swap_b32 v136, v138
    v_permlane16_swap_b32 v137, v139
    buffer_store_dwordx4 v[136:139], v248, s[16:19], s41 offen offset:3072
    s_branch A_pub
    .p2align 3
A_loop3:
    s_waitcnt lgkmcnt(0)
    v_mfma_f32_16x16x32_bf16 v[80:83], v[32:35], v[16:19], v[80:83]
    ds_read_b128 v[48:51], v3 offset:0
    v_mfma_f32_16x16x32_bf16 v[84:87], v[32:35], v[20:23], v[84:87]
    ds_read_b64_tr_b16 v[64:65], v4 offset:8192
    v_mfma_f32_16x16x32_bf16 v[88:91], v[32:35], v[24:27], v[88:91]
    ds_read_b64_tr_b16 v[66:67], v4 offset:9216
    v_mfma_f32_16x16x32_bf16 v[92:95], v[32:35], v[28:31], v[92:95]
    ds_read_b128 v[52:55], v3 offset:2048
    v_mfma_f32_16x16x32_bf16 v[96:99], v[16:19], v[36:39], v[96:99]
    ds_read_b64_tr_b16 v[68:69], v5 offset:8192
    v_mfma_f32_16x16x32_bf16 v[100:103], v[20:23], v[36:39], v[100:103]
    ds_read_b64_tr_b16 v[70:71], v5 offset:9216
    v_mfma_f32_16x16x32_bf16 v[104:107], v[24:27], v[36:39], v[104:107]
    ds_read_b128 v[56:59], v3 offset:4096
    v_mfma_f32_16x16x32_bf16 v[108:111], v[28:31], v[36:39], v[108:111]
    ds_read_b64_tr_b16 v[72:73], v6 offset:8192
    v_mfma_f32_16x16x32_bf16 v[112:115], v[16:19], v[40:43], v[112:115]
    ds_read_b64_tr_b16 v[74:75], v6 offset:9216
    v_mfma_f32_16x16x32_bf16 v[116:119], v[20:23], v[40:43], v[116:119]
    ds_read_b128 v[60:63], v3 offset:6144
    v_mfma_f32_16x16x32_bf16 v[120:123], v[24:27], v[40:43], v[120:123]
    ds_read_b64_tr_b16 v[76:77], v7 offset:8192
    v_mfma_f32_16x16x32_bf16 v[124:127], v[28:31], v[40:43], v[124:127]
    ds_read_b64_tr_b16 v[78:79], v7 offset:9216
    v_mfma_f32_16x16x32_bf16 v[128:131], v[16:19], v[44:47], v[128:131]
    s_add_u32 s29, s29, 1
    v_mfma_f32_16x16x32_bf16 v[132:135], v[20:23], v[44:47], v[132:135]
    s_and_b32 s28, s29, 3
    s_cselect_b32 s28, s30, 4294868992
    v_mfma_f32_16x16x32_bf16 v[136:139], v[24:27], v[44:47], v[136:139]
    s_cmp_eq_u32 s29, 10
    v_mfma_f32_16x16x32_bf16 v[140:143], v[28:31], v[44:47], v[140:143]
    v_mfma_f32_16x16x32_bf16 v[144:147], v[24:27], v[24:27], v[144:147]
    v_mfma_f32_16x16x32_bf16 v[148:151], v[28:31], v[28:31], v[148:151]
    v_smfmac_f32_16x16x64_bf16 v[152:155], v[8:11], v[24:31], v12
    v_smfmac_f32_16x16x64_bf16 v[156:159], v[8:11], v[40:47], v12
    s_waitcnt lgkmcnt(0)
    s_cbranch_scc1 A_last3
    s_barrier
    v_mfma_f32_16x16x32_bf16 v[80:83], v[64:67], v[48:51], v[80:83]
    v_add_u32 v2, s28, v2
    v_add_u32 v4, s28, v4
    v_mfma_f32_16x16x32_bf16 v[84:87], v[64:67], v[52:55], v[84:87]
    ds_read_b128 v[16:19], v2 offset:0
    v_mfma_f32_16x16x32_bf16 v[88:91], v[64:67], v[56:59], v[88:91]
    ds_read_b64_tr_b16 v[32:33], v4 offset:0
    v_mfma_f32_16x16x32_bf16 v[92:95], v[64:67], v[60:63], v[92:95]
    ds_read_b64_tr_b16 v[34:35], v4 offset:1024
    v_add_u32 v5, s28, v5
    v_mfma_f32_16x16x32_bf16 v[96:99], v[48:51], v[68:71], v[96:99]
    ds_read_b128 v[20:23], v2 offset:2048
    v_mfma_f32_16x16x32_bf16 v[100:103], v[52:55], v[68:71], v[100:103]
    ds_read_b64_tr_b16 v[36:37], v5 offset:0
    v_mfma_f32_16x16x32_bf16 v[104:107], v[56:59], v[68:71], v[104:107]
    ds_read_b64_tr_b16 v[38:39], v5 offset:1024
    v_add_u32 v6, s28, v6
    v_mfma_f32_16x16x32_bf16 v[108:111], v[60:63], v[68:71], v[108:111]
    ds_read_b128 v[24:27], v2 offset:4096
    v_mfma_f32_16x16x32_bf16 v[112:115], v[48:51], v[72:75], v[112:115]
    ds_read_b64_tr_b16 v[40:41], v6 offset:0
    v_mfma_f32_16x16x32_bf16 v[116:119], v[52:55], v[72:75], v[116:119]
    ds_read_b64_tr_b16 v[42:43], v6 offset:1024
    v_add_u32 v7, s28, v7
    v_mfma_f32_16x16x32_bf16 v[120:123], v[56:59], v[72:75], v[120:123]
    ds_read_b128 v[28:31], v2 offset:6144
    v_mfma_f32_16x16x32_bf16 v[124:127], v[60:63], v[72:75], v[124:127]
    ds_read_b64_tr_b16 v[44:45], v7 offset:0
    v_mfma_f32_16x16x32_bf16 v[128:131], v[48:51], v[76:79], v[128:131]
    ds_read_b64_tr_b16 v[46:47], v7 offset:1024
    v_mfma_f32_16x16x32_bf16 v[132:135], v[52:55], v[76:79], v[132:135]
    v_add_u32 v3, s28, v3
    v_mfma_f32_16x16x32_bf16 v[136:139], v[56:59], v[76:79], v[136:139]
    v_mfma_f32_16x16x32_bf16 v[140:143], v[60:63], v[76:79], v[140:143]
    v_mfma_f32_16x16x32_bf16 v[144:147], v[56:59], v[56:59], v[144:147]
    v_mfma_f32_16x16x32_bf16 v[148:151], v[60:63], v[60:63], v[148:151]
    v_smfmac_f32_16x16x64_bf16 v[152:155], v[8:11], v[56:63], v12
    v_smfmac_f32_16x16x64_bf16 v[156:159], v[8:11], v[72:79], v12
    s_branch A_loop3
A_last3:
    v_mfma_f32_16x16x32_bf16 v[144:147], v[56:59], v[56:59], v[144:147]
    v_mfma_f32_16x16x32_bf16 v[148:151], v[60:63], v[60:63], v[148:151]
    v_smfmac_f32_16x16x64_bf16 v[152:155], v[8:11], v[56:63], v12
    v_smfmac_f32_16x16x64_bf16 v[156:159], v[8:11], v[72:79], v12
    v_mfma_f32_16x16x32_bf16 v[80:83], v[64:67], v[48:51], v[80:83]
    v_mfma_f32_16x16x32_bf16 v[84:87], v[64:67], v[52:55], v[84:87]
    v_mfma_f32_16x16x32_bf16 v[88:91], v[64:67], v[56:59], v[88:91]
    v_mfma_f32_16x16x32_bf16 v[92:95], v[64:67], v[60:63], v[92:95]
    v_mfma_f32_16x16x32_bf16 v[96:99], v[48:51], v[68:71], v[96:99]
    v_mfma_f32_16x16x32_bf16 v[100:103], v[52:55], v[68:71], v[100:103]
    v_cndmask_b32 v144, v144, v145, s[44:45]
    v_cndmask_b32 v148, v148, v149, s[44:45]
    v_cndmask_b32 v144, v144, v146, s[46:47]
    v_cndmask_b32 v148, v148, v150, s[46:47]
    v_cndmask_b32 v144, v144, v147, s[52:53]
    v_cndmask_b32 v148, v148, v151, s[52:53]
    v_mfma_f32_16x16x32_bf16 v[104:107], v[56:59], v[68:71], v[104:107]
    v_add_f32 v152, v152, v153
    v_add_f32 v154, v154, v155
    v_mul_f32 v144, s35, v144
    v_mul_f32 v148, s35, v148
    v_mul_f32 v152, s35, v152
    v_mul_f32 v154, s35, v154
    v_mfma_f32_16x16x32_bf16 v[108:111], v[60:63], v[68:71], v[108:111]
    v_fma_f32 v144, -v152, v152, v144
    v_fma_f32 v148, -v154, v154, v148
    v_max_f32 v144, 0, v144
    v_max_f32 v148, 0, v148
    v_add_f32 v144, 0x3727c5ac, v144
    v_add_f32 v148, 0x3727c5ac, v148
    v_mfma_f32_16x16x32_bf16 v[112:115], v[48:51], v[72:75], v[112:115]
    v_rsq_f32 v144, v144
    v_rsq_f32 v148, v148
    v_add_f32 v156, v156, v157
    v_add_f32 v158, v158, v159
    v_mul_f32 v152, -v152, v144
    v_mul_f32 v154, -v154, v148
    v_mfma_f32_16x16x32_bf16 v[116:119], v[52:55], v[72:75], v[116:119]
    v_mul_f32 v146, s34, v144
    v_mul_f32 v150, s34, v148
    v_mul_f32 v147, s34, v152
    v_mul_f32 v151, s34, v154
    v_lshl_add_u32 v1, v13, 2, v250
    s_mov_b64 exec, s[54:55]
    ds_write_b64 v1, v[146:147] offset:2304
    ds_write_b64 v1, v[150:151] offset:2432
    ds_write_b32 v250, v156 offset:1408
    ds_write_b32 v250, v158 offset:1472
    ds_write2_b32 v250, v144, v148 offset0:96 offset1:112
    ds_write2_b32 v250, v152, v154 offset0:224 offset1:240
    s_mov_b64 exec, -1
    v_mfma_f32_16x16x32_bf16 v[120:123], v[56:59], v[72:75], v[120:123]
    v_mfma_f32_16x16x32_bf16 v[124:127], v[60:63], v[72:75], v[124:127]
    v_mov_b32 v12, 159888
    s_waitcnt lgkmcnt(0)
    s_barrier
    ds_read_b64 v[16:17], v1 offset:2048
    ds_read_b64 v[18:19], v1 offset:2176
    ds_read_b64 v[20:21], v1 offset:2304
    ds_read_b64 v[22:23], v1 offset:2432
    ds_read_b128 v[32:35], v251 offset:1280
    v_mfma_f32_16x16x32_bf16 v[128:131], v[48:51], v[76:79], v[128:131]
    ds_read_b32 v36, v250 offset:1344
    v_mfma_f32_16x16x32_bf16 v[132:135], v[52:55], v[76:79], v[132:135]
    ds_read_b32 v38, v250 offset:1408
    v_mfma_f32_16x16x32_bf16 v[136:139], v[56:59], v[76:79], v[136:139]
    ds_read_b32 v40, v250 offset:1472
    v_mfma_f32_16x16x32_bf16 v[140:143], v[60:63], v[76:79], v[140:143]
    ds_read_b32 v12, v12
    ds_read_b128 v[48:51], v251 offset:256
    ds_read_b128 v[64:67], v251 offset:768
    ds_read_b128 v[52:55], v251 offset:320
    ds_read_b128 v[68:71], v251 offset:832
    ds_read_b128 v[56:59], v251 offset:384
    ds_read_b128 v[72:75], v251 offset:896
    ds_read_b128 v[60:63], v251 offset:448
    ds_read_b128 v[76:79], v251 offset:960
A_epi1:
    s_waitcnt lgkmcnt(8)
    v_pk_mul_f32 v[80:81], v[80:81], v[16:17] op_sel_hi:[1,0]
    v_pk_mul_f32 v[82:83], v[82:83], v[16:17] op_sel_hi:[1,0]
    v_pk_mul_f32 v[84:85], v[84:85], v[18:19] op_sel_hi:[1,0]
    v_pk_mul_f32 v[86:87], v[86:87], v[18:19] op_sel_hi:[1,0]
    v_pk_fma_f32 v[80:81], v[32:33], v[16:17], v[80:81] op_sel:[0,1,0]
    v_pk_fma_f32 v[82:83], v[34:35], v[16:17], v[82:83] op_sel:[0,1,0]
    v_pk_fma_f32 v[84:85], v[32:33], v[18:19], v[84:85] op_sel:[0,1,0]
    v_pk_fma_f32 v[86:87], v[34:35], v[18:19], v[86:87] op_sel:[0,1,0]
    v_cvt_pk_bf16_f32 v80, v80, v81
    v_cvt_pk_bf16_f32 v81, v82, v83
    v_cvt_pk_bf16_f32 v82, v84, v85
    v_cvt_pk_bf16_f32 v83, v86, v87
    v_pk_mul_f32 v[88:89], v[88:89], v[20:21] op_sel_hi:[1,0]
    v_pk_mul_f32 v[90:91], v[90:91], v[20:21] op_sel_hi:[1,0]
    v_permlane16_swap_b32 v80, v82
    v_permlane16_swap_b32 v81, v83
    buffer_store_dwordx4 v[80:83], v246, s[16:19], s40 offen offset:0
    v_pk_mul_f32 v[92:93], v[92:93], v[22:23] op_sel_hi:[1,0]
    v_pk_mul_f32 v[94:95], v[94:95], v[22:23] op_sel_hi:[1,0]
    v_pk_fma_f32 v[88:89], v[32:33], v[20:21], v[88:89] op_sel:[0,1,0]
    v_pk_fma_f32 v[90:91], v[34:35], v[20:21], v[90:91] op_sel:[0,1,0]
    v_pk_fma_f32 v[92:93], v[32:33], v[22:23], v[92:93] op_sel:[0,1,0]
    v_pk_fma_f32 v[94:95], v[34:35], v[22:23], v[94:95] op_sel:[0,1,0]
    v_cvt_pk_bf16_f32 v88, v88, v89
    v_cvt_pk_bf16_f32 v89, v90, v91
    v_cvt_pk_bf16_f32 v90, v92, v93
    v_cvt_pk_bf16_f32 v91, v94, v95
    s_waitcnt lgkmcnt(0)
    v_pk_mul_f32 v[96:97], v[96:97], v[48:49]
    v_pk_mul_f32 v[98:99], v[98:99], v[50:51]
    v_pk_mul_f32 v[100:101], v[100:101], v[52:53]
    v_pk_mul_f32 v[102:103], v[102:103], v[54:55]
    v_permlane16_swap_b32 v88, v90
    v_permlane16_swap_b32 v89, v91
    buffer_store_dwordx4 v[88:91], v246, s[16:19], s41 offen offset:0
    v_pk_fma_f32 v[96:97], v[64:65], v[36:37], v[96:97] op_sel_hi:[1,0,1]
    v_pk_fma_f32 v[98:99], v[66:67], v[36:37], v[98:99] op_sel_hi:[1,0,1]
    v_pk_fma_f32 v[100:101], v[68:69], v[36:37], v[100:101] op_sel_hi:[1,0,1]
    v_pk_fma_f32 v[102:103], v[70:71], v[36:37], v[102:103] op_sel_hi:[1,0,1]
    v_cvt_pk_bf16_f32 v96, v96, v97
    v_cvt_pk_bf16_f32 v97, v98, v99
    v_cvt_pk_bf16_f32 v98, v100, v101
    v_cvt_pk_bf16_f32 v99, v102, v103
    buffer_store_dwordx4 v[96:99], v247, s[16:19], s42 offen offset:0
    v_pk_mul_f32 v[104:105], v[104:105], v[56:57]
    v_pk_mul_f32 v[106:107], v[106:107], v[58:59]
    v_pk_mul_f32 v[108:109], v[108:109], v[60:61]
    v_pk_mul_f32 v[110:111], v[110:111], v[62:63]
    v_pk_fma_f32 v[104:105], v[72:73], v[36:37], v[104:105] op_sel_hi:[1,0,1]
    v_pk_fma_f32 v[106:107], v[74:75], v[36:37], v[106:107] op_sel_hi:[1,0,1]
    v_pk_fma_f32 v[108:109], v[76:77], v[36:37], v[108:109] op_sel_hi:[1,0,1]
    v_pk_fma_f32 v[110:111], v[78:79], v[36:37], v[110:111] op_sel_hi:[1,0,1]
    v_cvt_pk_bf16_f32 v104, v104, v105
    v_cvt_pk_bf16_f32 v105, v106, v107
    v_cvt_pk_bf16_f32 v106, v108, v109
    v_cvt_pk_bf16_f32 v107, v110, v111
    buffer_store_dwordx4 v[104:107], v247, s[16:19], s42 offen offset:1280
    v_pk_mul_f32 v[112:113], v[112:113], v[48:49]
    v_pk_mul_f32 v[114:115], v[114:115], v[50:51]
    v_pk_mul_f32 v[116:117], v[116:117], v[52:53]
    v_pk_mul_f32 v[118:119], v[118:119], v[54:55]
    v_pk_fma_f32 v[112:113], v[64:65], v[38:39], v[112:113] op_sel_hi:[1,0,1]
    v_pk_fma_f32 v[114:115], v[66:67], v[38:39], v[114:115] op_sel_hi:[1,0,1]
    v_pk_fma_f32 v[116:117], v[68:69], v[38:39], v[116:117] op_sel_hi:[1,0,1]
    v_pk_fma_f32 v[118:119], v[70:71], v[38:39], v[118:119] op_sel_hi:[1,0,1]
    v_cvt_pk_bf16_f32 v112, v112, v113
    v_cvt_pk_bf16_f32 v113, v114, v115
    v_cvt_pk_bf16_f32 v114, v116, v117
    v_cvt_pk_bf16_f32 v115, v118, v119
    buffer_store_dwordx4 v[112:115], v248, s[16:19], s42 offen offset:0
    v_pk_mul_f32 v[120:121], v[120:121], v[56:57]
    v_pk_mul_f32 v[122:123], v[122:123], v[58:59]
    v_pk_mul_f32 v[124:125], v[124:125], v[60:61]
    v_pk_mul_f32 v[126:127], v[126:127], v[62:63]
    v_pk_fma_f32 v[120:121], v[72:73], v[38:39], v[120:121] op_sel_hi:[1,0,1]
    v_pk_fma_f32 v[122:123], v[74:75], v[38:39], v[122:123] op_sel_hi:[1,0,1]
    v_pk_fma_f32 v[124:125], v[76:77], v[38:39], v[124:125] op_sel_hi:[1,0,1]
    v_pk_fma_f32 v[126:127], v[78:79], v[38:39], v[126:127] op_sel_hi:[1,0,1]
    v_cvt_pk_bf16_f32 v120, v120, v121
    v_cvt_pk_bf16_f32 v121, v122, v123
    v_cvt_pk_bf16_f32 v122, v124, v125
    v_cvt_pk_bf16_f32 v123, v126, v127
    buffer_store_dwordx4 v[120:123], v248, s[16:19], s42 offen offset:1280
    v_pk_mul_f32 v[128:129], v[128:129], v[48:49]
    v_pk_mul_f32 v[130:131], v[130:131], v[50:51]
    v_pk_mul_f32 v[132:133], v[132:133], v[52:53]
    v_pk_mul_f32 v[134:135], v[134:135], v[54:55]
    v_pk_fma_f32 v[128:129], v[64:65], v[40:41], v[128:129] op_sel_hi:[1,0,1]
    v_pk_fma_f32 v[130:131], v[66:67], v[40:41], v[130:131] op_sel_hi:[1,0,1]
    v_pk_fma_f32 v[132:133], v[68:69], v[40:41], v[132:133] op_sel_hi:[1,0,1]
    v_pk_fma_f32 v[134:135], v[70:71], v[40:41], v[134:135] op_sel_hi:[1,0,1]
    v_cvt_pk_bf16_f32 v128, v128, v129
    v_cvt_pk_bf16_f32 v129, v130, v131
    v_cvt_pk_bf16_f32 v130, v132, v133
    v_cvt_pk_bf16_f32 v131, v134, v135
    buffer_store_dwordx4 v[128:131], v249, s[16:19], s42 offen offset:0
    v_pk_mul_f32 v[136:137], v[136:137], v[56:57]
    v_pk_mul_f32 v[138:139], v[138:139], v[58:59]
    v_pk_mul_f32 v[140:141], v[140:141], v[60:61]
    v_pk_mul_f32 v[142:143], v[142:143], v[62:63]
    v_pk_fma_f32 v[136:137], v[72:73], v[40:41], v[136:137] op_sel_hi:[1,0,1]
    v_pk_fma_f32 v[138:139], v[74:75], v[40:41], v[138:139] op_sel_hi:[1,0,1]
    v_pk_fma_f32 v[140:141], v[76:77], v[40:41], v[140:141] op_sel_hi:[1,0,1]
    v_pk_fma_f32 v[142:143], v[78:79], v[40:41], v[142:143] op_sel_hi:[1,0,1]
    v_cvt_pk_bf16_f32 v136, v136, v137
    v_cvt_pk_bf16_f32 v137, v138, v139
    v_cvt_pk_bf16_f32 v138, v140, v141
    v_cvt_pk_bf16_f32 v139, v142, v143
    buffer_store_dwordx4 v[136:139], v249, s[16:19], s42 offen offset:1280
A_pub:
    v_readfirstlane_b32 s3, v12
    s_lshl_b32 s21, s33, 2
    s_and_b32 s22, s32, 3
    s_add_u32 s21, s21, s22
    s_lshr_b32 s22, s32, 2
    s_lshr_b32 s23, s21, 1
    s_and_b32 s26, s21, 1
    s_mul_i32 s27, s23, 163840
    s_lshr_b32 s30, s20, 2
    s_and_b32 s31, s20, 3
    s_mul_i32 s55, s30, 18432
    s_mul_i32 s42, s31, 2304
    s_add_u32 s55, s55, s42
    s_add_u32 s55, s55, 123008
    s_sub_u32 s23, s32, 24
    s_cmp_lt_u32 s23, 5
    s_cselect_b32 s23, 2, 0
    s_cmp_lt_u32 s32, 24
    s_cselect_b32 s23, 1, s23
B_setup:
    s_add_u32 s28, s27, 2621440
    s_mul_i32 s29, s21, 81920
    s_add_u32 s29, s29, 5242880
    s_lshl_b32 s40, s22, 3
    s_lshl_b32 s41, s31, 1
    s_add_u32 s40, s40, s41
    s_mul_i32 s41, s40, 2560
    s_add_u32 s41, s41, s27
    s_mul_i32 s24, s30, 2560
    s_add_u32 s53, s41, s24
    s_sub_u32 s52, s41, s24
    s_add_u32 s52, s52, 2560
    s_mov_b32 s44, 0x0033ffff
    s_mov_b32 s45, 0x0033ffff
    s_mul_i32 s35, s30, 81920
    s_add_u32 s35, s35, s28
    s_mul_i32 s34, s31, 2560
    s_add_u32 s34, s34, s35
    s_add_u32 s34, s34, 5120
    s_mul_i32 s25, s30, 40960
    s_add_u32 s25, s25, s29
    s_mul_i32 s54, s31, 1280
    s_add_u32 s54, s54, s25
    s_add_u32 s54, s54, 256
    s_lshl_b32 s39, s21, 3
    s_add_u32 s39, s39, s22
    s_mul_i32 s39, s39, 14336
    s_add_u32 s39, s39, 7864320
    v_mov_b32 v1, v244
    v_mov_b32 v7, v241
    v_mov_b32 v8, v242
    v_mov_b32 v9, v240
    v_mov_b32 v15, v243
    s_lshl_b32 s36, s33, 13
    s_add_u32 s36, s36, 11534336
    s_lshl_b32 s42, s32, 4
    s_lshl_b32 s43, s20, 2
    s_add_u32 s42, s42, s43
    s_add_u32 s42, s42, s36
    s_mov_b32 s8, s68
    s_and_b32 s9, s69, 0xffff
    s_mov_b32 s10, 819200
    s_mov_b32 s11, 0x20000
    s_mov_b32 s48, s72
    s_and_b32 s49, s73, 0xffff
    s_mov_b32 s50, 1280
    s_mov_b32 s51, 0x20000
    s_mov_b32 s56, s80
    s_and_b32 s57, s81, 0xffff
    s_mov_b32 s58, 2621440
    s_mov_b32 s59, 0x20000
    s_cmp_eq_u32 s30, 0
    s_cselect_b32 s64, s74, s76
    s_cselect_b32 s65, s75, s77
    s_and_b32 s65, s65, 0xffff
    s_mov_b32 s66, 1966080
    s_mov_b32 s67, 0x20000
    s_mov_b32 s60, s78
    s_and_b32 s61, s79, 0xffff
    s_mov_b32 s62, 1966080
    s_mov_b32 s63, 0x20000
    s_mul_i32 s37, s20, 7680
    s_mul_i32 s38, s20, 960
    s_mul_i32 s47, s30, 10304
    s_lshl_b32 s43, s31, 10
    s_add_u32 s47, s47, s43
    s_mul_i32 s43, s20, 2560
    s_cmp_eq_u32 s23, 2
    s_cselect_b32 s47, s43, s47
    s_add_u32 s47, s47, 102400
    s_mov_b32 s46, 0
    s_cmp_lt_u32 s20, 4
    s_cbranch_scc0 B_s2
    s_waitcnt vmcnt(0)
    s_mov_b64 exec, 1
    s_cmp_eq_u32 s3, 0
    s_cbranch_scc1 B_slowpub
    buffer_store_dword v227, off, s[16:19], s42
B_pubd:
    s_mov_b64 exec, -1
B_s2:
    s_cmp_eq_u32 s20, 4
    s_cbranch_scc0 B_go
    v_lshlrev_b32 v13, 3, v0
    s_mov_b32 s42, 262144
B_poll:
    buffer_load_dwordx2 v[16:17], v13, s[16:19], s36 offen sc1
    s_sub_u32 s42, s42, 1
    s_cbranch_scc1 B_go
    s_waitcnt vmcnt(0)
    v_and_b32 v16, v16, v17
    v_cmp_ne_u32 vcc, 1, v16
    s_cbranch_vccnz B_poll
B_go:
    s_mov_b32 m0, s55
    s_mov_b32 s36, 262144
    s_barrier
    buffer_load_dwordx2 v[88:89], v239, s[16:19], s41 offen
    buffer_load_dwordx2 v[94:95], v209, s[16:19], s35 offen
    buffer_load_dwordx4 v[80:83], v208, s[16:19], s52 offen
    buffer_load_dwordx4 v[98:101], v208, s[16:19], s35 offen
    buffer_load_dwordx4 v[84:87], v208, s[16:19], s53 offen
    s_add_u32 s42, s35, 2560
    buffer_load_dwordx2 v[90:91], v209, s[16:19], s42 offen
    s_mov_b64 exec, s[44:45]
    buffer_load_dwordx4 v[160:163], v210, s[16:19], s25 offen
    buffer_load_dwordx4 v[164:167], v210, s[16:19], s25 offen offset:640
    s_mov_b64 exec, -1
    s_waitcnt vmcnt(6)
    v_mfma_f32_32x32x4_2b_bf16 v[16:47], v[94:95], v[88:89], 0 cbsz:1 abid:0
    buffer_load_dwordx4 v[102:105], v208, s[16:19], s35 offen offset:2560
    s_add_u32 m0, s55, 0
    s_add_u32 s42, s34, 0
    buffer_load_dwordx4 v208, s[16:19], s42 offen lds
    s_add_u32 s42, s54, 0
    buffer_load_dwordx4 v9, s[16:19], s42 offen offset:1024 lds
    buffer_load_dword v216, s[16:19], s42 offen offset:2048 lds
    s_add_u32 s42, s35, 7680
    buffer_load_dwordx2 v[92:93], v209, s[16:19], s42 offen
    s_waitcnt vmcnt(8)
    s_nop 7
    v_mfma_f32_32x32x16_bf16 v[16:31], v[98:101], v[80:83], v[16:31]
    v_mfma_f32_32x32x16_bf16 v[32:47], v[98:101], v[84:87], v[32:47]
    s_nop 10
    v_exp_f32 v16, v16
    v_exp_f32 v17, v17
    s_setprio 3
    s_waitcnt vmcnt(7)
    v_exp_f32 v18, v18
    v_exp_f32 v19, v19
    v_exp_f32 v20, v20
    v_exp_f32 v21, v21
    v_mfma_f32_32x32x4_2b_bf16 v[48:79], v[90:91], v[88:89], 0 cbsz:1 abid:0
    s_waitcnt vmcnt(5)
    v_exp_f32 v22, v22
    v_exp_f32 v23, v23
    v_exp_f32 v24, v24
    v_exp_f32 v25, v25
    v_exp_f32 v26, v26
    v_exp_f32 v27, v27
    v_exp_f32 v28, v28
    v_exp_f32 v29, v29
    v_smfmac_f32_32x32x32_bf16 v[176:191], v[160:163], v[16:23], v211
    v_exp_f32 v30, v30
    v_exp_f32 v31, v31
    v_exp_f32 v32, v32
    v_exp_f32 v33, v33
    v_smfmac_f32_32x32x32_bf16 v[176:191], v[164:167], v[24:31], v211
    s_waitcnt vmcnt(0)
    s_mov_b64 exec, 1
    ds_add_u32 v215, v227
    s_mov_b64 exec, -1
    v_exp_f32 v34, v34
    v_exp_f32 v35, v35
    v_exp_f32 v36, v36
    v_exp_f32 v37, v37
    v_mfma_f32_32x32x16_bf16 v[48:63], v[102:105], v[80:83], v[48:63]
    ds_read_b32 v14, v215
    v_exp_f32 v38, v38
    v_exp_f32 v39, v39
    v_exp_f32 v40, v40
    v_exp_f32 v41, v41
    v_mfma_f32_32x32x16_bf16 v[64:79], v[102:105], v[84:87], v[64:79]
B_chk0:
    s_waitcnt lgkmcnt(0)
    v_cmp_gt_u32 vcc, 4, v14
    s_cbranch_vccnz B_spin0
B_chkd0:
    ds_read_b128 v[98:101], v213 offset:0
    s_mov_b64 exec, s[44:45]
    ds_read_b128 v[168:171], v214 offset:0
    ds_read_b128 v[172:175], v214 offset:640
    s_mov_b64 exec, -1
    v_exp_f32 v42, v42
    v_exp_f32 v43, v43
    v_exp_f32 v44, v44
    v_exp_f32 v45, v45
    v_smfmac_f32_32x32x32_bf16 v[192:207], v[160:163], v[32:39], v211
    s_add_u32 m0, s55, 9216
    s_add_u32 s42, s34, 10240
    buffer_load_dwordx4 v208, s[16:19], s42 offen lds
    s_add_u32 s42, s54, 5120
    buffer_load_dwordx4 v9, s[16:19], s42 offen offset:1024 lds
    buffer_load_dword v216, s[16:19], s42 offen offset:2048 lds
    v_exp_f32 v46, v46
    v_exp_f32 v47, v47
    v_exp_f32 v48, v48
    v_exp_f32 v49, v49
    v_smfmac_f32_32x32x32_bf16 v[192:207], v[164:167], v[40:47], v211
    s_setprio 2
    s_waitcnt lgkmcnt(0)
    ds_read_b128 v[102:105], v213 offset:2304
    v_exp_f32 v50, v50
    v_exp_f32 v51, v51
    v_exp_f32 v52, v52
    v_exp_f32 v53, v53
    v_mfma_f32_32x32x4_2b_bf16 v[16:47], v[90:91], v[88:89], 0 cbsz:1 abid:1
    s_mov_b64 exec, s[44:45]
    ds_read_b128 v[160:163], v214 offset:2304
    ds_read_b128 v[164:167], v214 offset:2944
    s_mov_b64 exec, -1
    v_exp_f32 v54, v54
    v_exp_f32 v55, v55
    v_exp_f32 v56, v56
    v_exp_f32 v57, v57
    v_exp_f32 v58, v58
    v_exp_f32 v59, v59
    v_exp_f32 v60, v60
    v_exp_f32 v61, v61
    v_smfmac_f32_32x32x32_bf16 v[176:191], v[168:171], v[48:55], v211
    s_add_u32 s42, s35, 12800
    buffer_load_dwordx2 v[94:95], v209, s[16:19], s42 offen
    s_add_u32 s42, s35, 17920
    buffer_load_dwordx2 v[96:97], v209, s[16:19], s42 offen
    v_exp_f32 v62, v62
    v_exp_f32 v63, v63
    v_exp_f32 v64, v64
    v_exp_f32 v65, v65
    v_smfmac_f32_32x32x32_bf16 v[176:191], v[172:175], v[56:63], v211
    v_exp_f32 v66, v66
    v_exp_f32 v67, v67
    v_exp_f32 v68, v68
    v_exp_f32 v69, v69
    v_mfma_f32_32x32x16_bf16 v[16:31], v[98:101], v[80:83], v[16:31]
    v_exp_f32 v70, v70
    v_exp_f32 v71, v71
    v_exp_f32 v72, v72
    v_exp_f32 v73, v73
    v_mfma_f32_32x32x16_bf16 v[32:47], v[98:101], v[84:87], v[32:47]
    buffer_store_dwordx2 v[232:233], v234, s[16:19], s39 offen offset:1536 sc1
    s_mov_b64 exec, 33554431
    buffer_load_dword v10, v219, s[8:11], 0 offen
    s_mov_b64 exec, -1
    v_exp_f32 v74, v74
    v_exp_f32 v75, v75
    v_exp_f32 v76, v76
    v_exp_f32 v77, v77
    v_smfmac_f32_32x32x32_bf16 v[192:207], v[168:171], v[64:71], v211
    v_exp_f32 v78, v78
    v_exp_f32 v79, v79
    v_exp_f32 v16, v16
    v_exp_f32 v17, v17
    v_smfmac_f32_32x32x32_bf16 v[192:207], v[172:175], v[72:79], v211
    s_setprio 1
    s_waitcnt lgkmcnt(0)
    ds_read_b128 v[98:101], v213 offset:4608
    v_exp_f32 v18, v18
    v_exp_f32 v19, v19
    v_exp_f32 v20, v20
    v_exp_f32 v21, v21
    v_mfma_f32_32x32x4_2b_bf16 v[48:79], v[92:93], v[88:89], 0 cbsz:1 abid:0
    s_mov_b64 exec, s[44:45]
    ds_read_b128 v[168:171], v214 offset:4608
    ds_read_b128 v[172:175], v214 offset:5248
    s_mov_b64 exec, -1
    v_exp_f32 v22, v22
    v_exp_f32 v23, v23
    v_exp_f32 v24, v24
    v_exp_f32 v25, v25
    v_exp_f32 v26, v26
    v_exp_f32 v27, v27
    v_exp_f32 v28, v28
    v_exp_f32 v29, v29
    v_smfmac_f32_32x32x32_bf16 v[176:191], v[160:163], v[16:23], v211
    v_exp_f32 v30, v30
    v_exp_f32 v31, v31
    v_exp_f32 v32, v32
    v_exp_f32 v33, v33
    v_smfmac_f32_32x32x32_bf16 v[176:191], v[164:167], v[24:31], v211
    v_exp_f32 v34, v34
    v_exp_f32 v35, v35
    v_exp_f32 v36, v36
    v_exp_f32 v37, v37
    v_mfma_f32_32x32x16_bf16 v[48:63], v[102:105], v[80:83], v[48:63]
    v_exp_f32 v38, v38
    v_exp_f32 v39, v39
    v_exp_f32 v40, v40
    v_exp_f32 v41, v41
    v_mfma_f32_32x32x16_bf16 v[64:79], v[102:105], v[84:87], v[64:79]
    v_exp_f32 v42, v42
    v_exp_f32 v43, v43
    v_exp_f32 v44, v44
    v_exp_f32 v45, v45
    v_smfmac_f32_32x32x32_bf16 v[192:207], v[160:163], v[32:39], v211
    v_exp_f32 v46, v46
    v_exp_f32 v47, v47
    v_exp_f32 v48, v48
    v_exp_f32 v49, v49
    v_smfmac_f32_32x32x32_bf16 v[192:207], v[164:167], v[40:47], v211
    s_setprio 0
    s_waitcnt lgkmcnt(0)
    ds_read_b128 v[102:105], v213 offset:6912
    v_exp_f32 v50, v50
    v_exp_f32 v51, v51
    v_exp_f32 v52, v52
    v_exp_f32 v53, v53
    v_mfma_f32_32x32x4_2b_bf16 v[16:47], v[92:93], v[88:89], 0 cbsz:1 abid:1
    s_mov_b64 exec, s[44:45]
    ds_read_b128 v[160:163], v214 offset:6912
    ds_read_b128 v[164:167], v214 offset:7552
    s_mov_b64 exec, -1
    v_exp_f32 v54, v54
    v_exp_f32 v55, v55
    v_exp_f32 v56, v56
    v_exp_f32 v57, v57
    v_exp_f32 v58, v58
    v_exp_f32 v59, v59
    v_exp_f32 v60, v60
    v_exp_f32 v61, v61
    v_smfmac_f32_32x32x32_bf16 v[176:191], v[168:171], v[48:55], v211
    v_exp_f32 v62, v62
    v_exp_f32 v63, v63
    v_exp_f32 v64, v64
    v_exp_f32 v65, v65
    v_smfmac_f32_32x32x32_bf16 v[176:191], v[172:175], v[56:63], v211
    s_waitcnt vmcnt(2) lgkmcnt(0)
    s_mov_b64 exec, 1
    ds_add_u32 v231, v227
    s_mov_b64 exec, -1
    v_exp_f32 v66, v66
    v_exp_f32 v67, v67
    v_exp_f32 v68, v68
    v_exp_f32 v69, v69
    v_mfma_f32_32x32x16_bf16 v[16:31], v[98:101], v[80:83], v[16:31]
    v_exp_f32 v70, v70
    v_exp_f32 v71, v71
    v_exp_f32 v72, v72
    v_exp_f32 v73, v73
    v_mfma_f32_32x32x16_bf16 v[32:47], v[98:101], v[84:87], v[32:47]
    v_exp_f32 v74, v74
    v_exp_f32 v75, v75
    v_exp_f32 v76, v76
    v_exp_f32 v77, v77
    v_smfmac_f32_32x32x32_bf16 v[192:207], v[168:171], v[64:71], v211
    ds_read_b32 v14, v231
    v_exp_f32 v78, v78
    v_exp_f32 v79, v79
    v_exp_f32 v16, v16
    v_exp_f32 v17, v17
    v_smfmac_f32_32x32x32_bf16 v[192:207], v[172:175], v[72:79], v211
    s_setprio 3
B_chk1:
    s_waitcnt lgkmcnt(0)
    v_cmp_gt_u32 vcc, 8, v14
    s_cbranch_vccnz B_spin1
B_chkd1:
    ds_read_b128 v[98:101], v213 offset:9216
    v_exp_f32 v18, v18
    v_exp_f32 v19, v19
    v_exp_f32 v20, v20
    v_exp_f32 v21, v21
    v_mfma_f32_32x32x4_2b_bf16 v[48:79], v[94:95], v[88:89], 0 cbsz:1 abid:0
    s_mov_b64 exec, s[44:45]
    ds_read_b128 v[168:171], v214 offset:9216
    ds_read_b128 v[172:175], v214 offset:9856
    s_mov_b64 exec, -1
    v_exp_f32 v22, v22
    v_exp_f32 v23, v23
    v_exp_f32 v24, v24
    v_exp_f32 v25, v25
    v_exp_f32 v26, v26
    v_exp_f32 v27, v27
    v_exp_f32 v28, v28
    v_exp_f32 v29, v29
    v_smfmac_f32_32x32x32_bf16 v[176:191], v[160:163], v[16:23], v211
    s_add_u32 m0, s55, 0
    s_add_u32 s42, s34, 20480
    buffer_load_dwordx4 v208, s[16:19], s42 offen lds
    v_exp_f32 v30, v30
    v_exp_f32 v31, v31
    v_exp_f32 v32, v32
    v_exp_f32 v33, v33
    v_smfmac_f32_32x32x32_bf16 v[176:191], v[164:167], v[24:31], v211
    s_add_u32 s42, s54, 10240
    buffer_load_dwordx4 v9, s[16:19], s42 offen offset:1024 lds
    buffer_load_dword v216, s[16:19], s42 offen offset:2048 lds
    v_exp_f32 v34, v34
    v_exp_f32 v35, v35
    v_exp_f32 v36, v36
    v_exp_f32 v37, v37
    v_mfma_f32_32x32x16_bf16 v[48:63], v[102:105], v[80:83], v[48:63]
    s_add_u32 s42, s35, 23040
    buffer_load_dwordx2 v[90:91], v209, s[16:19], s42 offen
    v_exp_f32 v38, v38
    v_exp_f32 v39, v39
    v_exp_f32 v40, v40
    v_exp_f32 v41, v41
    v_mfma_f32_32x32x16_bf16 v[64:79], v[102:105], v[84:87], v[64:79]
    s_add_u32 s42, s35, 28160
    buffer_load_dwordx2 v[92:93], v209, s[16:19], s42 offen
    v_exp_f32 v42, v42
    v_exp_f32 v43, v43
    v_exp_f32 v44, v44
    v_exp_f32 v45, v45
    v_smfmac_f32_32x32x32_bf16 v[192:207], v[160:163], v[32:39], v211
    v_exp_f32 v46, v46
    v_exp_f32 v47, v47
    v_exp_f32 v48, v48
    v_exp_f32 v49, v49
    v_smfmac_f32_32x32x32_bf16 v[192:207], v[164:167], v[40:47], v211
    s_setprio 2
    s_waitcnt lgkmcnt(0)
    ds_read_b128 v[102:105], v213 offset:11520
    v_exp_f32 v50, v50
    v_exp_f32 v51, v51
    v_exp_f32 v52, v52
    v_exp_f32 v53, v53
    v_mfma_f32_32x32x4_2b_bf16 v[16:47], v[94:95], v[88:89], 0 cbsz:1 abid:1
    s_mov_b64 exec, s[44:45]
    ds_read_b128 v[160:163], v214 offset:11520
    ds_read_b128 v[164:167], v214 offset:12160
    s_mov_b64 exec, -1
    v_exp_f32 v54, v54
    v_exp_f32 v55, v55
    v_exp_f32 v56, v56
    v_exp_f32 v57, v57
    v_exp_f32 v58, v58
    v_exp_f32 v59, v59
    v_exp_f32 v60, v60
    v_exp_f32 v61, v61
    v_smfmac_f32_32x32x32_bf16 v[176:191], v[168:171], v[48:55], v211
    s_add_u32 m0, s38, 0
    s_add_u32 s42, s37, 0
    buffer_load_dwordx4 v212, s[8:11], s42 offen lds
    v_exp_f32 v62, v62
    v_exp_f32 v63, v63
    v_exp_f32 v64, v64
    v_exp_f32 v65, v65
    v_smfmac_f32_32x32x32_bf16 v[176:191], v[172:175], v[56:63], v211
    s_add_u32 m0, s38, 7680
    s_add_u32 s42, s37, 61440
    buffer_load_dwordx4 v212, s[8:11], s42 offen lds
    v_exp_f32 v66, v66
    v_exp_f32 v67, v67
    v_exp_f32 v68, v68
    v_exp_f32 v69, v69
    v_mfma_f32_32x32x16_bf16 v[16:31], v[98:101], v[80:83], v[16:31]
    v_exp_f32 v70, v70
    v_exp_f32 v71, v71
    v_exp_f32 v72, v72
    v_exp_f32 v73, v73
    v_mfma_f32_32x32x16_bf16 v[32:47], v[98:101], v[84:87], v[32:47]
    buffer_store_dwordx2 v[232:233], v234, s[16:19], s39 offen offset:1024 sc1
    s_mov_b64 exec, 63
    s_mov_b32 s42, 0
    buffer_load_dword v10, v220, s[64:67], s42 offen
    s_mov_b64 exec, 15
    s_mov_b32 s42, 0
    buffer_load_dword v10, v221, s[60:63], s42 offen
    s_mov_b64 exec, -1
    v_exp_f32 v74, v74
    v_exp_f32 v75, v75
    v_exp_f32 v76, v76
    v_exp_f32 v77, v77
    v_smfmac_f32_32x32x32_bf16 v[192:207], v[168:171], v[64:71], v211
    v_exp_f32 v78, v78
    v_exp_f32 v79, v79
    v_exp_f32 v16, v16
    v_exp_f32 v17, v17
    v_smfmac_f32_32x32x32_bf16 v[192:207], v[172:175], v[72:79], v211
    s_setprio 1
    s_waitcnt lgkmcnt(0)
    ds_read_b128 v[98:101], v213 offset:13824
    v_exp_f32 v18, v18
    v_exp_f32 v19, v19
    v_exp_f32 v20, v20
    v_exp_f32 v21, v21
    v_mfma_f32_32x32x4_2b_bf16 v[48:79], v[96:97], v[88:89], 0 cbsz:1 abid:0
    s_mov_b64 exec, s[44:45]
    ds_read_b128 v[168:171], v214 offset:13824
    ds_read_b128 v[172:175], v214 offset:14464
    s_mov_b64 exec, -1
    v_exp_f32 v22, v22
    v_exp_f32 v23, v23
    v_exp_f32 v24, v24
    v_exp_f32 v25, v25
    v_exp_f32 v26, v26
    v_exp_f32 v27, v27
    v_exp_f32 v28, v28
    v_exp_f32 v29, v29
    v_smfmac_f32_32x32x32_bf16 v[176:191], v[160:163], v[16:23], v211
    v_exp_f32 v30, v30
    v_exp_f32 v31, v31
    v_exp_f32 v32, v32
    v_exp_f32 v33, v33
    v_smfmac_f32_32x32x32_bf16 v[176:191], v[164:167], v[24:31], v211
    v_exp_f32 v34, v34
    v_exp_f32 v35, v35
    v_exp_f32 v36, v36
    v_exp_f32 v37, v37
    v_mfma_f32_32x32x16_bf16 v[48:63], v[102:105], v[80:83], v[48:63]
    v_exp_f32 v38, v38
    v_exp_f32 v39, v39
    v_exp_f32 v40, v40
    v_exp_f32 v41, v41
    v_mfma_f32_32x32x16_bf16 v[64:79], v[102:105], v[84:87], v[64:79]
    v_exp_f32 v42, v42
    v_exp_f32 v43, v43
    v_exp_f32 v44, v44
    v_exp_f32 v45, v45
    v_smfmac_f32_32x32x32_bf16 v[192:207], v[160:163], v[32:39], v211
    v_exp_f32 v46, v46
    v_exp_f32 v47, v47
    v_exp_f32 v48, v48
    v_exp_f32 v49, v49
    v_smfmac_f32_32x32x32_bf16 v[192:207], v[164:167], v[40:47], v211
    s_setprio 0
    s_waitcnt lgkmcnt(0)
    ds_read_b128 v[102:105], v213 offset:16128
    v_exp_f32 v50, v50
    v_exp_f32 v51, v51
    v_exp_f32 v52, v52
    v_exp_f32 v53, v53
    v_mfma_f32_32x32x4_2b_bf16 v[16:47], v[96:97], v[88:89], 0 cbsz:1 abid:1
    s_mov_b64 exec, s[44:45]
    ds_read_b128 v[160:163], v214 offset:16128
    ds_read_b128 v[164:167], v214 offset:16768
    s_mov_b64 exec, -1
    v_exp_f32 v54, v54
    v_exp_f32 v55, v55
    v_exp_f32 v56, v56
    v_exp_f32 v57, v57
    v_exp_f32 v58, v58
    v_exp_f32 v59, v59
    v_exp_f32 v60, v60
    v_exp_f32 v61, v61
    v_smfmac_f32_32x32x32_bf16 v[176:191], v[168:171], v[48:55], v211
    v_exp_f32 v62, v62
    v_exp_f32 v63, v63
    v_exp_f32 v64, v64
    v_exp_f32 v65, v65
    v_smfmac_f32_32x32x32_bf16 v[176:191], v[172:175], v[56:63], v211
    s_waitcnt vmcnt(5) lgkmcnt(0)
    s_mov_b64 exec, 1
    ds_add_u32 v231, v227
    s_mov_b64 exec, -1
    v_exp_f32 v66, v66
    v_exp_f32 v67, v67
    v_exp_f32 v68, v68
    v_exp_f32 v69, v69
    v_mfma_f32_32x32x16_bf16 v[16:31], v[98:101], v[80:83], v[16:31]
    v_exp_f32 v70, v70
    v_exp_f32 v71, v71
    v_exp_f32 v72, v72
    v_exp_f32 v73, v73
    v_mfma_f32_32x32x16_bf16 v[32:47], v[98:101], v[84:87], v[32:47]
    v_exp_f32 v74, v74
    v_exp_f32 v75, v75
    v_exp_f32 v76, v76
    v_exp_f32 v77, v77
    v_smfmac_f32_32x32x32_bf16 v[192:207], v[168:171], v[64:71], v211
    ds_read_b32 v14, v231
    v_exp_f32 v78, v78
    v_exp_f32 v79, v79
    v_exp_f32 v16, v16
    v_exp_f32 v17, v17
    v_smfmac_f32_32x32x32_bf16 v[192:207], v[172:175], v[72:79], v211
    s_setprio 3
B_chk2:
    s_waitcnt lgkmcnt(0)
    v_cmp_gt_u32 vcc, 16, v14
    s_cbranch_vccnz B_spin2
B_chkd2:
    ds_read_b128 v[98:101], v213 offset:0
    v_exp_f32 v18, v18
    v_exp_f32 v19, v19
    v_exp_f32 v20, v20
    v_exp_f32 v21, v21
    v_mfma_f32_32x32x4_2b_bf16 v[48:79], v[90:91], v[88:89], 0 cbsz:1 abid:0
    s_mov_b64 exec, s[44:45]
    ds_read_b128 v[168:171], v214 offset:0
    ds_read_b128 v[172:175], v214 offset:640
    s_mov_b64 exec, -1
    v_exp_f32 v22, v22
    v_exp_f32 v23, v23
    v_exp_f32 v24, v24
    v_exp_f32 v25, v25
    v_exp_f32 v26, v26
    v_exp_f32 v27, v27
    v_exp_f32 v28, v28
    v_exp_f32 v29, v29
    v_smfmac_f32_32x32x32_bf16 v[176:191], v[160:163], v[16:23], v211
    s_add_u32 m0, s55, 9216
    s_add_u32 s42, s34, 30720
    buffer_load_dwordx4 v208, s[16:19], s42 offen lds
    v_exp_f32 v30, v30
    v_exp_f32 v31, v31
    v_exp_f32 v32, v32
    v_exp_f32 v33, v33
    v_smfmac_f32_32x32x32_bf16 v[176:191], v[164:167], v[24:31], v211
    s_add_u32 s42, s54, 15360
    buffer_load_dwordx4 v9, s[16:19], s42 offen offset:1024 lds
    buffer_load_dword v216, s[16:19], s42 offen offset:2048 lds
    v_exp_f32 v34, v34
    v_exp_f32 v35, v35
    v_exp_f32 v36, v36
    v_exp_f32 v37, v37
    v_mfma_f32_32x32x16_bf16 v[48:63], v[102:105], v[80:83], v[48:63]
    s_add_u32 s42, s35, 33280
    buffer_load_dwordx2 v[94:95], v209, s[16:19], s42 offen
    v_exp_f32 v38, v38
    v_exp_f32 v39, v39
    v_exp_f32 v40, v40
    v_exp_f32 v41, v41
    v_mfma_f32_32x32x16_bf16 v[64:79], v[102:105], v[84:87], v[64:79]
    s_add_u32 s42, s35, 38400
    buffer_load_dwordx2 v[96:97], v209, s[16:19], s42 offen
    v_exp_f32 v42, v42
    v_exp_f32 v43, v43
    v_exp_f32 v44, v44
    v_exp_f32 v45, v45
    v_smfmac_f32_32x32x32_bf16 v[192:207], v[160:163], v[32:39], v211
    v_exp_f32 v46, v46
    v_exp_f32 v47, v47
    v_exp_f32 v48, v48
    v_exp_f32 v49, v49
    v_smfmac_f32_32x32x32_bf16 v[192:207], v[164:167], v[40:47], v211
    s_setprio 2
    s_waitcnt lgkmcnt(0)
    ds_read_b128 v[102:105], v213 offset:2304
    v_exp_f32 v50, v50
    v_exp_f32 v51, v51
    v_exp_f32 v52, v52
    v_exp_f32 v53, v53
    v_mfma_f32_32x32x4_2b_bf16 v[16:47], v[90:91], v[88:89], 0 cbsz:1 abid:1
    s_mov_b64 exec, s[44:45]
    ds_read_b128 v[160:163], v214 offset:2304
    ds_read_b128 v[164:167], v214 offset:2944
    s_mov_b64 exec, -1
    v_exp_f32 v54, v54
    v_exp_f32 v55, v55
    v_exp_f32 v56, v56
    v_exp_f32 v57, v57
    v_exp_f32 v58, v58
    v_exp_f32 v59, v59
    v_exp_f32 v60, v60
    v_exp_f32 v61, v61
    v_smfmac_f32_32x32x32_bf16 v[176:191], v[168:171], v[48:55], v211
    s_add_u32 m0, s38, 15360
    s_add_u32 s42, s37, 122880
    buffer_load_dwordx4 v212, s[8:11], s42 offen lds
    v_exp_f32 v62, v62
    v_exp_f32 v63, v63
    v_exp_f32 v64, v64
    v_exp_f32 v65, v65
    v_smfmac_f32_32x32x32_bf16 v[176:191], v[172:175], v[56:63], v211
    s_add_u32 m0, s38, 23040
    s_add_u32 s42, s37, 184320
    buffer_load_dwordx4 v212, s[8:11], s42 offen lds
    v_exp_f32 v66, v66
    v_exp_f32 v67, v67
    v_exp_f32 v68, v68
    v_exp_f32 v69, v69
    v_mfma_f32_32x32x16_bf16 v[16:31], v[98:101], v[80:83], v[16:31]
    v_exp_f32 v70, v70
    v_exp_f32 v71, v71
    v_exp_f32 v72, v72
    v_exp_f32 v73, v73
    v_mfma_f32_32x32x16_bf16 v[32:47], v[98:101], v[84:87], v[32:47]
    buffer_store_dwordx2 v[232:233], v234, s[16:19], s39 offen offset:512 sc1
    s_mov_b64 exec, 63
    s_mov_b32 s42, 786432
    buffer_load_dword v10, v220, s[64:67], s42 offen
    s_mov_b64 exec, 15
    s_mov_b32 s42, 81920
    buffer_load_dword v10, v221, s[60:63], s42 offen
    s_mov_b64 exec, -1
    v_exp_f32 v74, v74
    v_exp_f32 v75, v75
    v_exp_f32 v76, v76
    v_exp_f32 v77, v77
    v_smfmac_f32_32x32x32_bf16 v[192:207], v[168:171], v[64:71], v211
    v_exp_f32 v78, v78
    v_exp_f32 v79, v79
    v_exp_f32 v16, v16
    v_exp_f32 v17, v17
    v_smfmac_f32_32x32x32_bf16 v[192:207], v[172:175], v[72:79], v211
    s_setprio 1
    s_waitcnt lgkmcnt(0)
    ds_read_b128 v[98:101], v213 offset:4608
    v_exp_f32 v18, v18
    v_exp_f32 v19, v19
    v_exp_f32 v20, v20
    v_exp_f32 v21, v21
    v_mfma_f32_32x32x4_2b_bf16 v[48:79], v[92:93], v[88:89], 0 cbsz:1 abid:0
    s_mov_b64 exec, s[44:45]
    ds_read_b128 v[168:171], v214 offset:4608
    ds_read_b128 v[172:175], v214 offset:5248
    s_mov_b64 exec, -1
    v_exp_f32 v22, v22
    v_exp_f32 v23, v23
    v_exp_f32 v24, v24
    v_exp_f32 v25, v25
    v_exp_f32 v26, v26
    v_exp_f32 v27, v27
    v_exp_f32 v28, v28
    v_exp_f32 v29, v29
    v_smfmac_f32_32x32x32_bf16 v[176:191], v[160:163], v[16:23], v211
    v_exp_f32 v30, v30
    v_exp_f32 v31, v31
    v_exp_f32 v32, v32
    v_exp_f32 v33, v33
    v_smfmac_f32_32x32x32_bf16 v[176:191], v[164:167], v[24:31], v211
    v_exp_f32 v34, v34
    v_exp_f32 v35, v35
    v_exp_f32 v36, v36
    v_exp_f32 v37, v37
    v_mfma_f32_32x32x16_bf16 v[48:63], v[102:105], v[80:83], v[48:63]
    v_exp_f32 v38, v38
    v_exp_f32 v39, v39
    v_exp_f32 v40, v40
    v_exp_f32 v41, v41
    v_mfma_f32_32x32x16_bf16 v[64:79], v[102:105], v[84:87], v[64:79]
    v_exp_f32 v42, v42
    v_exp_f32 v43, v43
    v_exp_f32 v44, v44
    v_exp_f32 v45, v45
    v_smfmac_f32_32x32x32_bf16 v[192:207], v[160:163], v[32:39], v211
    v_exp_f32 v46, v46
    v_exp_f32 v47, v47
    v_exp_f32 v48, v48
    v_exp_f32 v49, v49
    v_smfmac_f32_32x32x32_bf16 v[192:207], v[164:167], v[40:47], v211
    s_setprio 0
    s_waitcnt lgkmcnt(0)
    ds_read_b128 v[102:105], v213 offset:6912
    v_exp_f32 v50, v50
    v_exp_f32 v51, v51
    v_exp_f32 v52, v52
    v_exp_f32 v53, v53
    v_mfma_f32_32x32x4_2b_bf16 v[16:47], v[92:93], v[88:89], 0 cbsz:1 abid:1
    s_mov_b64 exec, s[44:45]
    ds_read_b128 v[160:163], v214 offset:6912
    ds_read_b128 v[164:167], v214 offset:7552
    s_mov_b64 exec, -1
    v_exp_f32 v54, v54
    v_exp_f32 v55, v55
    v_exp_f32 v56, v56
    v_exp_f32 v57, v57
    v_exp_f32 v58, v58
    v_exp_f32 v59, v59
    v_exp_f32 v60, v60
    v_exp_f32 v61, v61
    v_smfmac_f32_32x32x32_bf16 v[176:191], v[168:171], v[48:55], v211
    v_exp_f32 v62, v62
    v_exp_f32 v63, v63
    v_exp_f32 v64, v64
    v_exp_f32 v65, v65
    v_smfmac_f32_32x32x32_bf16 v[176:191], v[172:175], v[56:63], v211
    s_waitcnt vmcnt(5) lgkmcnt(0)
    s_mov_b64 exec, 1
    ds_add_u32 v231, v227
    s_mov_b64 exec, -1
    v_exp_f32 v66, v66
    v_exp_f32 v67, v67
    v_exp_f32 v68, v68
    v_exp_f32 v69, v69
    v_mfma_f32_32x32x16_bf16 v[16:31], v[98:101], v[80:83], v[16:31]
    v_exp_f32 v70, v70
    v_exp_f32 v71, v71
    v_exp_f32 v72, v72
    v_exp_f32 v73, v73
    v_mfma_f32_32x32x16_bf16 v[32:47], v[98:101], v[84:87], v[32:47]
    v_exp_f32 v74, v74
    v_exp_f32 v75, v75
    v_exp_f32 v76, v76
    v_exp_f32 v77, v77
    v_smfmac_f32_32x32x32_bf16 v[192:207], v[168:171], v[64:71], v211
    ds_read_b32 v14, v231
    v_exp_f32 v78, v78
    v_exp_f32 v79, v79
    v_exp_f32 v16, v16
    v_exp_f32 v17, v17
    v_smfmac_f32_32x32x32_bf16 v[192:207], v[172:175], v[72:79], v211
    s_setprio 3
B_chk3:
    s_waitcnt lgkmcnt(0)
    v_cmp_gt_u32 vcc, 24, v14
    s_cbranch_vccnz B_spin3
B_chkd3:
    ds_read_b128 v[98:101], v213 offset:9216
    v_exp_f32 v18, v18
    v_exp_f32 v19, v19
    v_exp_f32 v20, v20
    v_exp_f32 v21, v21
    v_mfma_f32_32x32x4_2b_bf16 v[48:79], v[94:95], v[88:89], 0 cbsz:1 abid:0
    s_mov_b64 exec, s[44:45]
    ds_read_b128 v[168:171], v214 offset:9216
    ds_read_b128 v[172:175], v214 offset:9856
    s_mov_b64 exec, -1
    v_exp_f32 v22, v22
    v_exp_f32 v23, v23
    v_exp_f32 v24, v24
    v_exp_f32 v25, v25
    v_exp_f32 v26, v26
    v_exp_f32 v27, v27
    v_exp_f32 v28, v28
    v_exp_f32 v29, v29
    v_smfmac_f32_32x32x32_bf16 v[176:191], v[160:163], v[16:23], v211
    s_add_u32 m0, s55, 0
    s_add_u32 s42, s34, 40960
    buffer_load_dwordx4 v208, s[16:19], s42 offen lds
    v_exp_f32 v30, v30
    v_exp_f32 v31, v31
    v_exp_f32 v32, v32
    v_exp_f32 v33, v33
    v_smfmac_f32_32x32x32_bf16 v[176:191], v[164:167], v[24:31], v211
    s_add_u32 s42, s54, 20480
    buffer_load_dwordx4 v9, s[16:19], s42 offen offset:1024 lds
    buffer_load_dword v216, s[16:19], s42 offen offset:2048 lds
    v_exp_f32 v34, v34
    v_exp_f32 v35, v35
    v_exp_f32 v36, v36
    v_exp_f32 v37, v37
    v_mfma_f32_32x32x16_bf16 v[48:63], v[102:105], v[80:83], v[48:63]
    s_add_u32 s42, s35, 43520
    buffer_load_dwordx2 v[90:91], v209, s[16:19], s42 offen
    v_exp_f32 v38, v38
    v_exp_f32 v39, v39
    v_exp_f32 v40, v40
    v_exp_f32 v41, v41
    v_mfma_f32_32x32x16_bf16 v[64:79], v[102:105], v[84:87], v[64:79]
    s_add_u32 s42, s35, 48640
    buffer_load_dwordx2 v[92:93], v209, s[16:19], s42 offen
    v_exp_f32 v42, v42
    v_exp_f32 v43, v43
    v_exp_f32 v44, v44
    v_exp_f32 v45, v45
    v_smfmac_f32_32x32x32_bf16 v[192:207], v[160:163], v[32:39], v211
    v_exp_f32 v46, v46
    v_exp_f32 v47, v47
    v_exp_f32 v48, v48
    v_exp_f32 v49, v49
    v_smfmac_f32_32x32x32_bf16 v[192:207], v[164:167], v[40:47], v211
    s_setprio 2
    s_waitcnt lgkmcnt(0)
    ds_read_b128 v[102:105], v213 offset:11520
    v_exp_f32 v50, v50
    v_exp_f32 v51, v51
    v_exp_f32 v52, v52
    v_exp_f32 v53, v53
    v_mfma_f32_32x32x4_2b_bf16 v[16:47], v[94:95], v[88:89], 0 cbsz:1 abid:1
    s_mov_b64 exec, s[44:45]
    ds_read_b128 v[160:163], v214 offset:11520
    ds_read_b128 v[164:167], v214 offset:12160
    s_mov_b64 exec, -1
    v_exp_f32 v54, v54
    v_exp_f32 v55, v55
    v_exp_f32 v56, v56
    v_exp_f32 v57, v57
    v_exp_f32 v58, v58
    v_exp_f32 v59, v59
    v_exp_f32 v60, v60
    v_exp_f32 v61, v61
    v_smfmac_f32_32x32x32_bf16 v[176:191], v[168:171], v[48:55], v211
    s_add_u32 m0, s38, 30720
    s_add_u32 s42, s37, 245760
    buffer_load_dwordx4 v212, s[8:11], s42 offen lds
    v_exp_f32 v62, v62
    v_exp_f32 v63, v63
    v_exp_f32 v64, v64
    v_exp_f32 v65, v65
    v_smfmac_f32_32x32x32_bf16 v[176:191], v[172:175], v[56:63], v211
    s_add_u32 m0, s38, 38400
    s_add_u32 s42, s37, 307200
    buffer_load_dwordx4 v212, s[8:11], s42 offen lds
    v_exp_f32 v66, v66
    v_exp_f32 v67, v67
    v_exp_f32 v68, v68
    v_exp_f32 v69, v69
    v_mfma_f32_32x32x16_bf16 v[16:31], v[98:101], v[80:83], v[16:31]
    v_exp_f32 v70, v70
    v_exp_f32 v71, v71
    v_exp_f32 v72, v72
    v_exp_f32 v73, v73
    v_mfma_f32_32x32x16_bf16 v[32:47], v[98:101], v[84:87], v[32:47]
    buffer_store_dwordx2 v[232:233], v234, s[16:19], s39 offen offset:0 sc1
    s_mov_b64 exec, 63
    s_mov_b32 s42, 1572864
    buffer_load_dword v10, v220, s[64:67], s42 offen
    s_mov_b64 exec, 15
    s_mov_b32 s42, 163840
    buffer_load_dword v10, v221, s[60:63], s42 offen
    s_mov_b64 exec, -1
    v_exp_f32 v74, v74
    v_exp_f32 v75, v75
    v_exp_f32 v76, v76
    v_exp_f32 v77, v77
    v_smfmac_f32_32x32x32_bf16 v[192:207], v[168:171], v[64:71], v211
    v_exp_f32 v78, v78
    v_exp_f32 v79, v79
    v_exp_f32 v16, v16
    v_exp_f32 v17, v17
    v_smfmac_f32_32x32x32_bf16 v[192:207], v[172:175], v[72:79], v211
    s_setprio 1
    s_waitcnt lgkmcnt(0)
    ds_read_b128 v[98:101], v213 offset:13824
    v_exp_f32 v18, v18
    v_exp_f32 v19, v19
    v_exp_f32 v20, v20
    v_exp_f32 v21, v21
    v_mfma_f32_32x32x4_2b_bf16 v[48:79], v[96:97], v[88:89], 0 cbsz:1 abid:0
    s_mov_b64 exec, s[44:45]
    ds_read_b128 v[168:171], v214 offset:13824
    ds_read_b128 v[172:175], v214 offset:14464
    s_mov_b64 exec, -1
    v_exp_f32 v22, v22
    v_exp_f32 v23, v23
    v_exp_f32 v24, v24
    v_exp_f32 v25, v25
    v_exp_f32 v26, v26
    v_exp_f32 v27, v27
    v_exp_f32 v28, v28
    v_exp_f32 v29, v29
    v_smfmac_f32_32x32x32_bf16 v[176:191], v[160:163], v[16:23], v211
    v_exp_f32 v30, v30
    v_exp_f32 v31, v31
    v_exp_f32 v32, v32
    v_exp_f32 v33, v33
    v_smfmac_f32_32x32x32_bf16 v[176:191], v[164:167], v[24:31], v211
    v_exp_f32 v34, v34
    v_exp_f32 v35, v35
    v_exp_f32 v36, v36
    v_exp_f32 v37, v37
    v_mfma_f32_32x32x16_bf16 v[48:63], v[102:105], v[80:83], v[48:63]
    v_exp_f32 v38, v38
    v_exp_f32 v39, v39
    v_exp_f32 v40, v40
    v_exp_f32 v41, v41
    v_mfma_f32_32x32x16_bf16 v[64:79], v[102:105], v[84:87], v[64:79]
    v_exp_f32 v42, v42
    v_exp_f32 v43, v43
    v_exp_f32 v44, v44
    v_exp_f32 v45, v45
    v_smfmac_f32_32x32x32_bf16 v[192:207], v[160:163], v[32:39], v211
    v_exp_f32 v46, v46
    v_exp_f32 v47, v47
    v_exp_f32 v48, v48
    v_exp_f32 v49, v49
    v_smfmac_f32_32x32x32_bf16 v[192:207], v[164:167], v[40:47], v211
    s_setprio 0
    s_waitcnt lgkmcnt(0)
    ds_read_b128 v[102:105], v213 offset:16128
    v_exp_f32 v50, v50
    v_exp_f32 v51, v51
    v_exp_f32 v52, v52
    v_exp_f32 v53, v53
    v_mfma_f32_32x32x4_2b_bf16 v[16:47], v[96:97], v[88:89], 0 cbsz:1 abid:1
    s_mov_b64 exec, s[44:45]
    ds_read_b128 v[160:163], v214 offset:16128
    ds_read_b128 v[164:167], v214 offset:16768
    s_mov_b64 exec, -1
    v_exp_f32 v54, v54
    v_exp_f32 v55, v55
    v_exp_f32 v56, v56
    v_exp_f32 v57, v57
    v_exp_f32 v58, v58
    v_exp_f32 v59, v59
    v_exp_f32 v60, v60
    v_exp_f32 v61, v61
    v_smfmac_f32_32x32x32_bf16 v[176:191], v[168:171], v[48:55], v211
    v_exp_f32 v62, v62
    v_exp_f32 v63, v63
    v_exp_f32 v64, v64
    v_exp_f32 v65, v65
    v_smfmac_f32_32x32x32_bf16 v[176:191], v[172:175], v[56:63], v211
    s_waitcnt vmcnt(5) lgkmcnt(0)
    s_mov_b64 exec, 1
    ds_add_u32 v231, v227
    s_mov_b64 exec, -1
    v_exp_f32 v66, v66
    v_exp_f32 v67, v67
    v_exp_f32 v68, v68
    v_exp_f32 v69, v69
    v_mfma_f32_32x32x16_bf16 v[16:31], v[98:101], v[80:83], v[16:31]
    v_exp_f32 v70, v70
    v_exp_f32 v71, v71
    v_exp_f32 v72, v72
    v_exp_f32 v73, v73
    v_mfma_f32_32x32x16_bf16 v[32:47], v[98:101], v[84:87], v[32:47]
    v_exp_f32 v74, v74
    v_exp_f32 v75, v75
    v_exp_f32 v76, v76
    v_exp_f32 v77, v77
    v_smfmac_f32_32x32x32_bf16 v[192:207], v[168:171], v[64:71], v211
    ds_read_b32 v14, v231
    v_exp_f32 v78, v78
    v_exp_f32 v79, v79
    v_exp_f32 v16, v16
    v_exp_f32 v17, v17
    v_smfmac_f32_32x32x32_bf16 v[192:207], v[172:175], v[72:79], v211
    s_setprio 3
B_chk4:
    s_waitcnt lgkmcnt(0)
    v_cmp_gt_u32 vcc, 32, v14
    s_cbranch_vccnz B_spin4
B_chkd4:
    ds_read_b128 v[98:101], v213 offset:0
    v_exp_f32 v18, v18
    v_exp_f32 v19, v19
    v_exp_f32 v20, v20
    v_exp_f32 v21, v21
    v_mfma_f32_32x32x4_2b_bf16 v[48:79], v[90:91], v[88:89], 0 cbsz:1 abid:0
    s_mov_b64 exec, s[44:45]
    ds_read_b128 v[168:171], v214 offset:0
    ds_read_b128 v[172:175], v214 offset:640
    s_mov_b64 exec, -1
    v_exp_f32 v22, v22
    v_exp_f32 v23, v23
    v_exp_f32 v24, v24
    v_exp_f32 v25, v25
    v_exp_f32 v26, v26
    v_exp_f32 v27, v27
    v_exp_f32 v28, v28
    v_exp_f32 v29, v29
    v_smfmac_f32_32x32x32_bf16 v[176:191], v[160:163], v[16:23], v211
    s_add_u32 m0, s55, 9216
    s_add_u32 s42, s34, 51200
    buffer_load_dwordx4 v208, s[16:19], s42 offen lds
    v_exp_f32 v30, v30
    v_exp_f32 v31, v31
    v_exp_f32 v32, v32
    v_exp_f32 v33, v33
    v_smfmac_f32_32x32x32_bf16 v[176:191], v[164:167], v[24:31], v211
    s_add_u32 s42, s54, 25600
    buffer_load_dwordx4 v9, s[16:19], s42 offen offset:1024 lds
    buffer_load_dword v216, s[16:19], s42 offen offset:2048 lds
    v_exp_f32 v34, v34
    v_exp_f32 v35, v35
    v_exp_f32 v36, v36
    v_exp_f32 v37, v37
    v_mfma_f32_32x32x16_bf16 v[48:63], v[102:105], v[80:83], v[48:63]
    s_add_u32 s42, s35, 53760
    buffer_load_dwordx2 v[94:95], v209, s[16:19], s42 offen
    v_exp_f32 v38, v38
    v_exp_f32 v39, v39
    v_exp_f32 v40, v40
    v_exp_f32 v41, v41
    v_mfma_f32_32x32x16_bf16 v[64:79], v[102:105], v[84:87], v[64:79]
    s_add_u32 s42, s35, 58880
    buffer_load_dwordx2 v[96:97], v209, s[16:19], s42 offen
    v_exp_f32 v42, v42
    v_exp_f32 v43, v43
    v_exp_f32 v44, v44
    v_exp_f32 v45, v45
    v_smfmac_f32_32x32x32_bf16 v[192:207], v[160:163], v[32:39], v211
    v_exp_f32 v46, v46
    v_exp_f32 v47, v47
    v_exp_f32 v48, v48
    v_exp_f32 v49, v49
    v_smfmac_f32_32x32x32_bf16 v[192:207], v[164:167], v[40:47], v211
    s_setprio 2
    s_waitcnt lgkmcnt(0)
    ds_read_b128 v[102:105], v213 offset:2304
    v_exp_f32 v50, v50
    v_exp_f32 v51, v51
    v_exp_f32 v52, v52
    v_exp_f32 v53, v53
    v_mfma_f32_32x32x4_2b_bf16 v[16:47], v[90:91], v[88:89], 0 cbsz:1 abid:1
    s_mov_b64 exec, s[44:45]
    ds_read_b128 v[160:163], v214 offset:2304
    ds_read_b128 v[164:167], v214 offset:2944
    s_mov_b64 exec, -1
    v_exp_f32 v54, v54
    v_exp_f32 v55, v55
    v_exp_f32 v56, v56
    v_exp_f32 v57, v57
    v_exp_f32 v58, v58
    v_exp_f32 v59, v59
    v_exp_f32 v60, v60
    v_exp_f32 v61, v61
    v_smfmac_f32_32x32x32_bf16 v[176:191], v[168:171], v[48:55], v211
    s_add_u32 m0, s38, 46080
    s_add_u32 s42, s37, 368640
    buffer_load_dwordx4 v212, s[8:11], s42 offen lds
    v_exp_f32 v62, v62
    v_exp_f32 v63, v63
    v_exp_f32 v64, v64
    v_exp_f32 v65, v65
    v_smfmac_f32_32x32x32_bf16 v[176:191], v[172:175], v[56:63], v211
    s_add_u32 m0, s38, 53760
    s_add_u32 s42, s37, 430080
    buffer_load_dwordx4 v212, s[8:11], s42 offen lds
    v_exp_f32 v66, v66
    v_exp_f32 v67, v67
    v_exp_f32 v68, v68
    v_exp_f32 v69, v69
    v_mfma_f32_32x32x16_bf16 v[16:31], v[98:101], v[80:83], v[16:31]
    s_cmp_lg_u32 s23, 0
    s_cbranch_scc1 B_ff0
B_ffd0:
    v_exp_f32 v70, v70
    v_exp_f32 v71, v71
    v_exp_f32 v72, v72
    v_exp_f32 v73, v73
    v_mfma_f32_32x32x16_bf16 v[32:47], v[98:101], v[84:87], v[32:47]
    v_exp_f32 v74, v74
    v_exp_f32 v75, v75
    v_exp_f32 v76, v76
    v_exp_f32 v77, v77
    v_smfmac_f32_32x32x32_bf16 v[192:207], v[168:171], v[64:71], v211
    v_exp_f32 v78, v78
    v_exp_f32 v79, v79
    v_exp_f32 v16, v16
    v_exp_f32 v17, v17
    v_smfmac_f32_32x32x32_bf16 v[192:207], v[172:175], v[72:79], v211
    s_setprio 1
    s_waitcnt lgkmcnt(0)
    ds_read_b128 v[98:101], v213 offset:4608
    v_exp_f32 v18, v18
    v_exp_f32 v19, v19
    v_exp_f32 v20, v20
    v_exp_f32 v21, v21
    v_mfma_f32_32x32x4_2b_bf16 v[48:79], v[92:93], v[88:89], 0 cbsz:1 abid:0
    s_mov_b64 exec, s[44:45]
    ds_read_b128 v[168:171], v214 offset:4608
    ds_read_b128 v[172:175], v214 offset:5248
    s_mov_b64 exec, -1
    v_exp_f32 v22, v22
    v_exp_f32 v23, v23
    v_exp_f32 v24, v24
    v_exp_f32 v25, v25
    v_exp_f32 v26, v26
    v_exp_f32 v27, v27
    v_exp_f32 v28, v28
    v_exp_f32 v29, v29
    v_smfmac_f32_32x32x32_bf16 v[176:191], v[160:163], v[16:23], v211
    v_exp_f32 v30, v30
    v_exp_f32 v31, v31
    v_exp_f32 v32, v32
    v_exp_f32 v33, v33
    v_smfmac_f32_32x32x32_bf16 v[176:191], v[164:167], v[24:31], v211
    v_exp_f32 v34, v34
    v_exp_f32 v35, v35
    v_exp_f32 v36, v36
    v_exp_f32 v37, v37
    v_mfma_f32_32x32x16_bf16 v[48:63], v[102:105], v[80:83], v[48:63]
    v_exp_f32 v38, v38
    v_exp_f32 v39, v39
    v_exp_f32 v40, v40
    v_exp_f32 v41, v41
    v_mfma_f32_32x32x16_bf16 v[64:79], v[102:105], v[84:87], v[64:79]
    v_exp_f32 v42, v42
    v_exp_f32 v43, v43
    v_exp_f32 v44, v44
    v_exp_f32 v45, v45
    v_smfmac_f32_32x32x32_bf16 v[192:207], v[160:163], v[32:39], v211
    v_exp_f32 v46, v46
    v_exp_f32 v47, v47
    v_exp_f32 v48, v48
    v_exp_f32 v49, v49
    v_smfmac_f32_32x32x32_bf16 v[192:207], v[164:167], v[40:47], v211
    s_setprio 0
    s_waitcnt lgkmcnt(0)
    ds_read_b128 v[102:105], v213 offset:6912
    v_exp_f32 v50, v50
    v_exp_f32 v51, v51
    v_exp_f32 v52, v52
    v_exp_f32 v53, v53
    v_mfma_f32_32x32x4_2b_bf16 v[16:47], v[92:93], v[88:89], 0 cbsz:1 abid:1
    s_mov_b64 exec, s[44:45]
    ds_read_b128 v[160:163], v214 offset:6912
    ds_read_b128 v[164:167], v214 offset:7552
    s_mov_b64 exec, -1
    v_exp_f32 v54, v54
    v_exp_f32 v55, v55
    v_exp_f32 v56, v56
    v_exp_f32 v57, v57
    v_exp_f32 v58, v58
    v_exp_f32 v59, v59
    v_exp_f32 v60, v60
    v_exp_f32 v61, v61
    v_smfmac_f32_32x32x32_bf16 v[176:191], v[168:171], v[48:55], v211
    v_exp_f32 v62, v62
    v_exp_f32 v63, v63
    v_exp_f32 v64, v64
    v_exp_f32 v65, v65
    v_smfmac_f32_32x32x32_bf16 v[176:191], v[172:175], v[56:63], v211
    s_waitcnt vmcnt(2) lgkmcnt(0)
    s_mov_b64 exec, 1
    ds_add_u32 v231, v227
    s_mov_b64 exec, -1
    v_exp_f32 v66, v66
    v_exp_f32 v67, v67
    v_exp_f32 v68, v68
    v_exp_f32 v69, v69
    v_mfma_f32_32x32x16_bf16 v[16:31], v[98:101], v[80:83], v[16:31]
    s_cmp_eq_u32 s23, 2
    s_cbranch_scc1 B_f2r0
B_f2d0:
    v_exp_f32 v70, v70
    v_exp_f32 v71, v71
    v_exp_f32 v72, v72
    v_exp_f32 v73, v73
    v_mfma_f32_32x32x16_bf16 v[32:47], v[98:101], v[84:87], v[32:47]
    v_mov_b32 v11, 159904
    s_mov_b64 exec, 1
    ds_add_rtn_u32 v11, v11, v227
    s_mov_b64 exec, -1
    v_exp_f32 v74, v74
    v_exp_f32 v75, v75
    v_exp_f32 v76, v76
    v_exp_f32 v77, v77
    v_smfmac_f32_32x32x32_bf16 v[192:207], v[168:171], v[64:71], v211
    ds_read_b32 v14, v231
    v_exp_f32 v78, v78
    v_exp_f32 v79, v79
    v_exp_f32 v16, v16
    v_exp_f32 v17, v17
    v_smfmac_f32_32x32x32_bf16 v[192:207], v[172:175], v[72:79], v211
    s_setprio 3
B_chk5:
    s_waitcnt lgkmcnt(0)
    v_cmp_gt_u32 vcc, 40, v14
    s_cbranch_vccnz B_spin5
B_chkd5:
    ds_read_b128 v[98:101], v213 offset:9216
    v_exp_f32 v18, v18
    v_exp_f32 v19, v19
    v_exp_f32 v20, v20
    v_exp_f32 v21, v21
    v_mfma_f32_32x32x4_2b_bf16 v[48:79], v[94:95], v[88:89], 0 cbsz:1 abid:0
    s_mov_b64 exec, s[44:45]
    ds_read_b128 v[168:171], v214 offset:9216
    ds_read_b128 v[172:175], v214 offset:9856
    s_mov_b64 exec, -1
    v_exp_f32 v22, v22
    v_exp_f32 v23, v23
    v_exp_f32 v24, v24
    v_exp_f32 v25, v25
    v_exp_f32 v26, v26
    v_exp_f32 v27, v27
    v_exp_f32 v28, v28
    v_exp_f32 v29, v29
    v_smfmac_f32_32x32x32_bf16 v[176:191], v[160:163], v[16:23], v211
    s_add_u32 m0, s55, 0
    s_add_u32 s42, s34, 61440
    buffer_load_dwordx4 v208, s[16:19], s42 offen lds
    v_exp_f32 v30, v30
    v_exp_f32 v31, v31
    v_exp_f32 v32, v32
    v_exp_f32 v33, v33
    v_smfmac_f32_32x32x32_bf16 v[176:191], v[164:167], v[24:31], v211
    s_add_u32 s42, s54, 30720
    buffer_load_dwordx4 v9, s[16:19], s42 offen offset:1024 lds
    buffer_load_dword v216, s[16:19], s42 offen offset:2048 lds
    v_exp_f32 v34, v34
    v_exp_f32 v35, v35
    v_exp_f32 v36, v36
    v_exp_f32 v37, v37
    v_mfma_f32_32x32x16_bf16 v[48:63], v[102:105], v[80:83], v[48:63]
    s_add_u32 s42, s35, 64000
    buffer_load_dwordx2 v[90:91], v209, s[16:19], s42 offen
    v_exp_f32 v38, v38
    v_exp_f32 v39, v39
    v_exp_f32 v40, v40
    v_exp_f32 v41, v41
    v_mfma_f32_32x32x16_bf16 v[64:79], v[102:105], v[84:87], v[64:79]
    s_add_u32 s42, s35, 69120
    buffer_load_dwordx2 v[92:93], v209, s[16:19], s42 offen
    v_exp_f32 v42, v42
    v_exp_f32 v43, v43
    v_exp_f32 v44, v44
    v_exp_f32 v45, v45
    v_smfmac_f32_32x32x32_bf16 v[192:207], v[160:163], v[32:39], v211
    v_readfirstlane_b32 s42, v11
    s_cmp_eq_u32 s42, 7
    s_cbranch_scc1 B_mark
B_markd:
    v_exp_f32 v46, v46
    v_exp_f32 v47, v47
    v_exp_f32 v48, v48
    v_exp_f32 v49, v49
    v_smfmac_f32_32x32x32_bf16 v[192:207], v[164:167], v[40:47], v211
    s_setprio 2
    s_waitcnt lgkmcnt(0)
    ds_read_b128 v[102:105], v213 offset:11520
    v_exp_f32 v50, v50
    v_exp_f32 v51, v51
    v_exp_f32 v52, v52
    v_exp_f32 v53, v53
    v_mfma_f32_32x32x4_2b_bf16 v[16:47], v[94:95], v[88:89], 0 cbsz:1 abid:1
    s_mov_b64 exec, s[44:45]
    ds_read_b128 v[160:163], v214 offset:11520
    ds_read_b128 v[164:167], v214 offset:12160
    s_mov_b64 exec, -1
    v_exp_f32 v54, v54
    v_exp_f32 v55, v55
    v_exp_f32 v56, v56
    v_exp_f32 v57, v57
    v_exp_f32 v58, v58
    v_exp_f32 v59, v59
    v_exp_f32 v60, v60
    v_exp_f32 v61, v61
    v_smfmac_f32_32x32x32_bf16 v[176:191], v[168:171], v[48:55], v211
    s_add_u32 m0, s38, 61440
    s_add_u32 s42, s37, 491520
    buffer_load_dwordx4 v212, s[8:11], s42 offen lds
    v_exp_f32 v62, v62
    v_exp_f32 v63, v63
    v_exp_f32 v64, v64
    v_exp_f32 v65, v65
    v_smfmac_f32_32x32x32_bf16 v[176:191], v[172:175], v[56:63], v211
    s_add_u32 m0, s38, 69120
    s_add_u32 s42, s37, 552960
    buffer_load_dwordx4 v212, s[8:11], s42 offen lds
    v_exp_f32 v66, v66
    v_exp_f32 v67, v67
    v_exp_f32 v68, v68
    v_exp_f32 v69, v69
    v_mfma_f32_32x32x16_bf16 v[16:31], v[98:101], v[80:83], v[16:31]
    s_cmp_lg_u32 s23, 0
    s_cbranch_scc1 B_ff1
B_ffd1:
    v_exp_f32 v70, v70
    v_exp_f32 v71, v71
    v_exp_f32 v72, v72
    v_exp_f32 v73, v73
    v_mfma_f32_32x32x16_bf16 v[32:47], v[98:101], v[84:87], v[32:47]
    v_exp_f32 v74, v74
    v_exp_f32 v75, v75
    v_exp_f32 v76, v76
    v_exp_f32 v77, v77
    v_smfmac_f32_32x32x32_bf16 v[192:207], v[168:171], v[64:71], v211
    v_exp_f32 v78, v78
    v_exp_f32 v79, v79
    v_exp_f32 v16, v16
    v_exp_f32 v17, v17
    v_smfmac_f32_32x32x32_bf16 v[192:207], v[172:175], v[72:79], v211
    s_setprio 1
    s_waitcnt lgkmcnt(0)
    ds_read_b128 v[98:101], v213 offset:13824
    v_exp_f32 v18, v18
    v_exp_f32 v19, v19
    v_exp_f32 v20, v20
    v_exp_f32 v21, v21
    v_mfma_f32_32x32x4_2b_bf16 v[48:79], v[96:97], v[88:89], 0 cbsz:1 abid:0
    s_mov_b64 exec, s[44:45]
    ds_read_b128 v[168:171], v214 offset:13824
    ds_read_b128 v[172:175], v214 offset:14464
    s_mov_b64 exec, -1
    v_exp_f32 v22, v22
    v_exp_f32 v23, v23
    v_exp_f32 v24, v24
    v_exp_f32 v25, v25
    v_exp_f32 v26, v26
    v_exp_f32 v27, v27
    v_exp_f32 v28, v28
    v_exp_f32 v29, v29
    v_smfmac_f32_32x32x32_bf16 v[176:191], v[160:163], v[16:23], v211
    v_exp_f32 v30, v30
    v_exp_f32 v31, v31
    v_exp_f32 v32, v32
    v_exp_f32 v33, v33
    v_smfmac_f32_32x32x32_bf16 v[176:191], v[164:167], v[24:31], v211
    v_exp_f32 v34, v34
    v_exp_f32 v35, v35
    v_exp_f32 v36, v36
    v_exp_f32 v37, v37
    v_mfma_f32_32x32x16_bf16 v[48:63], v[102:105], v[80:83], v[48:63]
    v_exp_f32 v38, v38
    v_exp_f32 v39, v39
    v_exp_f32 v40, v40
    v_exp_f32 v41, v41
    v_mfma_f32_32x32x16_bf16 v[64:79], v[102:105], v[84:87], v[64:79]
    v_exp_f32 v42, v42
    v_exp_f32 v43, v43
    v_exp_f32 v44, v44
    v_exp_f32 v45, v45
    v_smfmac_f32_32x32x32_bf16 v[192:207], v[160:163], v[32:39], v211
    s_lshl_b32 s42, s32, 3
    s_add_u32 s42, s42, s20
    s_cmp_eq_u32 s42, 255
    s_cbranch_scc1 B_col
B_cold:
    v_exp_f32 v46, v46
    v_exp_f32 v47, v47
    v_exp_f32 v48, v48
    v_exp_f32 v49, v49
    v_smfmac_f32_32x32x32_bf16 v[192:207], v[164:167], v[40:47], v211
    s_setprio 0
    s_waitcnt lgkmcnt(0)
    ds_read_b128 v[102:105], v213 offset:16128
    v_exp_f32 v50, v50
    v_exp_f32 v51, v51
    v_exp_f32 v52, v52
    v_exp_f32 v53, v53
    v_mfma_f32_32x32x4_2b_bf16 v[16:47], v[96:97], v[88:89], 0 cbsz:1 abid:1
    s_mov_b64 exec, s[44:45]
    ds_read_b128 v[160:163], v214 offset:16128
    ds_read_b128 v[164:167], v214 offset:16768
    s_mov_b64 exec, -1
    v_exp_f32 v54, v54
    v_exp_f32 v55, v55
    v_exp_f32 v56, v56
    v_exp_f32 v57, v57
    v_exp_f32 v58, v58
    v_exp_f32 v59, v59
    v_exp_f32 v60, v60
    v_exp_f32 v61, v61
    v_smfmac_f32_32x32x32_bf16 v[176:191], v[168:171], v[48:55], v211
    v_exp_f32 v62, v62
    v_exp_f32 v63, v63
    v_exp_f32 v64, v64
    v_exp_f32 v65, v65
    v_smfmac_f32_32x32x32_bf16 v[176:191], v[172:175], v[56:63], v211
    s_waitcnt vmcnt(2) lgkmcnt(0)
    s_mov_b64 exec, 1
    ds_add_u32 v231, v227
    s_mov_b64 exec, -1
    v_exp_f32 v66, v66
    v_exp_f32 v67, v67
    v_exp_f32 v68, v68
    v_exp_f32 v69, v69
    v_mfma_f32_32x32x16_bf16 v[16:31], v[98:101], v[80:83], v[16:31]
    s_cmp_eq_u32 s23, 2
    s_cbranch_scc1 B_f2r1
B_f2d1:
    v_exp_f32 v70, v70
    v_exp_f32 v71, v71
    v_exp_f32 v72, v72
    v_exp_f32 v73, v73
    v_mfma_f32_32x32x16_bf16 v[32:47], v[98:101], v[84:87], v[32:47]
    s_lshl_b32 s42, s32, 3
    s_add_u32 s42, s42, s20
    s_cmp_eq_u32 s42, 255
    s_cbranch_scc1 B_col2
B_col2d:
    v_exp_f32 v74, v74
    v_exp_f32 v75, v75
    v_exp_f32 v76, v76
    v_exp_f32 v77, v77
    v_smfmac_f32_32x32x32_bf16 v[192:207], v[168:171], v[64:71], v211
    ds_read_b32 v14, v231
    v_exp_f32 v78, v78
    v_exp_f32 v79, v79
    v_exp_f32 v16, v16
    v_exp_f32 v17, v17
    v_smfmac_f32_32x32x32_bf16 v[192:207], v[172:175], v[72:79], v211
    s_setprio 3
B_chk6:
    s_waitcnt lgkmcnt(0)
    v_cmp_gt_u32 vcc, 48, v14
    s_cbranch_vccnz B_spin6
B_chkd6:
    ds_read_b128 v[98:101], v213 offset:0
    v_exp_f32 v18, v18
    v_exp_f32 v19, v19
    v_exp_f32 v20, v20
    v_exp_f32 v21, v21
    v_mfma_f32_32x32x4_2b_bf16 v[48:79], v[90:91], v[88:89], 0 cbsz:1 abid:0
    s_mov_b64 exec, s[44:45]
    ds_read_b128 v[168:171], v214 offset:0
    ds_read_b128 v[172:175], v214 offset:640
    s_mov_b64 exec, -1
    v_exp_f32 v22, v22
    v_exp_f32 v23, v23
    v_exp_f32 v24, v24
    v_exp_f32 v25, v25
    v_exp_f32 v26, v26
    v_exp_f32 v27, v27
    v_exp_f32 v28, v28
    v_exp_f32 v29, v29
    v_smfmac_f32_32x32x32_bf16 v[176:191], v[160:163], v[16:23], v211
    s_add_u32 m0, s55, 9216
    s_add_u32 s42, s34, 71680
    buffer_load_dwordx4 v208, s[16:19], s42 offen lds
    v_exp_f32 v30, v30
    v_exp_f32 v31, v31
    v_exp_f32 v32, v32
    v_exp_f32 v33, v33
    v_smfmac_f32_32x32x32_bf16 v[176:191], v[164:167], v[24:31], v211
    s_add_u32 s42, s54, 35840
    buffer_load_dwordx4 v9, s[16:19], s42 offen offset:1024 lds
    buffer_load_dword v216, s[16:19], s42 offen offset:2048 lds
    v_exp_f32 v34, v34
    v_exp_f32 v35, v35
    v_exp_f32 v36, v36
    v_exp_f32 v37, v37
    v_mfma_f32_32x32x16_bf16 v[48:63], v[102:105], v[80:83], v[48:63]
    s_add_u32 s42, s35, 74240
    buffer_load_dwordx2 v[94:95], v209, s[16:19], s42 offen
    v_exp_f32 v38, v38
    v_exp_f32 v39, v39
    v_exp_f32 v40, v40
    v_exp_f32 v41, v41
    v_mfma_f32_32x32x16_bf16 v[64:79], v[102:105], v[84:87], v[64:79]
    s_add_u32 s42, s35, 79360
    buffer_load_dwordx2 v[96:97], v209, s[16:19], s42 offen
    v_exp_f32 v42, v42
    v_exp_f32 v43, v43
    v_exp_f32 v44, v44
    v_exp_f32 v45, v45
    v_smfmac_f32_32x32x32_bf16 v[192:207], v[160:163], v[32:39], v211
    v_exp_f32 v46, v46
    v_exp_f32 v47, v47
    v_exp_f32 v48, v48
    v_exp_f32 v49, v49
    v_smfmac_f32_32x32x32_bf16 v[192:207], v[164:167], v[40:47], v211
    s_setprio 2
    s_waitcnt lgkmcnt(0)
    ds_read_b128 v[102:105], v213 offset:2304
    v_exp_f32 v50, v50
    v_exp_f32 v51, v51
    v_exp_f32 v52, v52
    v_exp_f32 v53, v53
    v_mfma_f32_32x32x4_2b_bf16 v[16:47], v[90:91], v[88:89], 0 cbsz:1 abid:1
    s_mov_b64 exec, s[44:45]
    ds_read_b128 v[160:163], v214 offset:2304
    ds_read_b128 v[164:167], v214 offset:2944
    s_mov_b64 exec, -1
    v_exp_f32 v54, v54
    v_exp_f32 v55, v55
    v_exp_f32 v56, v56
    v_exp_f32 v57, v57
    v_exp_f32 v58, v58
    v_exp_f32 v59, v59
    v_exp_f32 v60, v60
    v_exp_f32 v61, v61
    v_smfmac_f32_32x32x32_bf16 v[176:191], v[168:171], v[48:55], v211
    s_add_u32 m0, s38, 76800
    s_add_u32 s42, s37, 614400
    buffer_load_dwordx4 v212, s[8:11], s42 offen lds
    v_exp_f32 v62, v62
    v_exp_f32 v63, v63
    v_exp_f32 v64, v64
    v_exp_f32 v65, v65
    v_smfmac_f32_32x32x32_bf16 v[176:191], v[172:175], v[56:63], v211
    s_add_u32 m0, s38, 84480
    s_add_u32 s42, s37, 675840
    buffer_load_dwordx4 v212, s[8:11], s42 offen lds
    v_exp_f32 v66, v66
    v_exp_f32 v67, v67
    v_exp_f32 v68, v68
    v_exp_f32 v69, v69
    v_mfma_f32_32x32x16_bf16 v[16:31], v[98:101], v[80:83], v[16:31]
    s_cmp_lg_u32 s23, 0
    s_cbranch_scc1 B_ff2
B_ffd2:
    v_exp_f32 v70, v70
    v_exp_f32 v71, v71
    v_exp_f32 v72, v72
    v_exp_f32 v73, v73
    v_mfma_f32_32x32x16_bf16 v[32:47], v[98:101], v[84:87], v[32:47]
    v_exp_f32 v74, v74
    v_exp_f32 v75, v75
    v_exp_f32 v76, v76
    v_exp_f32 v77, v77
    v_smfmac_f32_32x32x32_bf16 v[192:207], v[168:171], v[64:71], v211
    v_exp_f32 v78, v78
    v_exp_f32 v79, v79
    v_exp_f32 v16, v16
    v_exp_f32 v17, v17
    v_smfmac_f32_32x32x32_bf16 v[192:207], v[172:175], v[72:79], v211
    s_setprio 1
    s_waitcnt lgkmcnt(0)
    ds_read_b128 v[98:101], v213 offset:4608
    v_exp_f32 v18, v18
    v_exp_f32 v19, v19
    v_exp_f32 v20, v20
    v_exp_f32 v21, v21
    v_mfma_f32_32x32x4_2b_bf16 v[48:79], v[92:93], v[88:89], 0 cbsz:1 abid:0
    s_mov_b64 exec, s[44:45]
    ds_read_b128 v[168:171], v214 offset:4608
    ds_read_b128 v[172:175], v214 offset:5248
    s_mov_b64 exec, -1
    v_exp_f32 v22, v22
    v_exp_f32 v23, v23
    v_exp_f32 v24, v24
    v_exp_f32 v25, v25
    v_exp_f32 v26, v26
    v_exp_f32 v27, v27
    v_exp_f32 v28, v28
    v_exp_f32 v29, v29
    v_smfmac_f32_32x32x32_bf16 v[176:191], v[160:163], v[16:23], v211
    v_exp_f32 v30, v30
    v_exp_f32 v31, v31
    v_exp_f32 v32, v32
    v_exp_f32 v33, v33
    v_smfmac_f32_32x32x32_bf16 v[176:191], v[164:167], v[24:31], v211
    v_exp_f32 v34, v34
    v_exp_f32 v35, v35
    v_exp_f32 v36, v36
    v_exp_f32 v37, v37
    v_mfma_f32_32x32x16_bf16 v[48:63], v[102:105], v[80:83], v[48:63]
    v_exp_f32 v38, v38
    v_exp_f32 v39, v39
    v_exp_f32 v40, v40
    v_exp_f32 v41, v41
    v_mfma_f32_32x32x16_bf16 v[64:79], v[102:105], v[84:87], v[64:79]
    v_exp_f32 v42, v42
    v_exp_f32 v43, v43
    v_exp_f32 v44, v44
    v_exp_f32 v45, v45
    v_smfmac_f32_32x32x32_bf16 v[192:207], v[160:163], v[32:39], v211
    v_exp_f32 v46, v46
    v_exp_f32 v47, v47
    v_exp_f32 v48, v48
    v_exp_f32 v49, v49
    v_smfmac_f32_32x32x32_bf16 v[192:207], v[164:167], v[40:47], v211
    s_setprio 0
    s_waitcnt lgkmcnt(0)
    ds_read_b128 v[102:105], v213 offset:6912
    v_exp_f32 v50, v50
    v_exp_f32 v51, v51
    v_exp_f32 v52, v52
    v_exp_f32 v53, v53
    v_mfma_f32_32x32x4_2b_bf16 v[16:47], v[92:93], v[88:89], 0 cbsz:1 abid:1
    s_mov_b64 exec, s[44:45]
    ds_read_b128 v[160:163], v214 offset:6912
    ds_read_b128 v[164:167], v214 offset:7552
    s_mov_b64 exec, -1
    v_exp_f32 v54, v54
    v_exp_f32 v55, v55
    v_exp_f32 v56, v56
    v_exp_f32 v57, v57
    v_exp_f32 v58, v58
    v_exp_f32 v59, v59
    v_exp_f32 v60, v60
    v_exp_f32 v61, v61
    v_smfmac_f32_32x32x32_bf16 v[176:191], v[168:171], v[48:55], v211
    v_exp_f32 v62, v62
    v_exp_f32 v63, v63
    v_exp_f32 v64, v64
    v_exp_f32 v65, v65
    v_smfmac_f32_32x32x32_bf16 v[176:191], v[172:175], v[56:63], v211
    s_waitcnt vmcnt(2) lgkmcnt(0)
    s_mov_b64 exec, 1
    ds_add_u32 v231, v227
    s_mov_b64 exec, -1
    v_exp_f32 v66, v66
    v_exp_f32 v67, v67
    v_exp_f32 v68, v68
    v_exp_f32 v69, v69
    v_mfma_f32_32x32x16_bf16 v[16:31], v[98:101], v[80:83], v[16:31]
    s_cmp_eq_u32 s23, 2
    s_cbranch_scc1 B_f2r2
B_f2d2:
    v_exp_f32 v70, v70
    v_exp_f32 v71, v71
    v_exp_f32 v72, v72
    v_exp_f32 v73, v73
    v_mfma_f32_32x32x16_bf16 v[32:47], v[98:101], v[84:87], v[32:47]
    v_exp_f32 v74, v74
    v_exp_f32 v75, v75
    v_exp_f32 v76, v76
    v_exp_f32 v77, v77
    v_smfmac_f32_32x32x32_bf16 v[192:207], v[168:171], v[64:71], v211
    ds_read_b32 v14, v231
    v_exp_f32 v78, v78
    v_exp_f32 v79, v79
    v_exp_f32 v16, v16
    v_exp_f32 v17, v17
    v_smfmac_f32_32x32x32_bf16 v[192:207], v[172:175], v[72:79], v211
    s_setprio 3
B_chk7:
    s_waitcnt lgkmcnt(0)
    v_cmp_gt_u32 vcc, 56, v14
    s_cbranch_vccnz B_spin7
B_chkd7:
    ds_read_b128 v[98:101], v213 offset:9216
    v_exp_f32 v18, v18
    v_exp_f32 v19, v19
    v_exp_f32 v20, v20
    v_exp_f32 v21, v21
    v_mfma_f32_32x32x4_2b_bf16 v[48:79], v[94:95], v[88:89], 0 cbsz:1 abid:0
    s_mov_b64 exec, s[44:45]
    ds_read_b128 v[168:171], v214 offset:9216
    ds_read_b128 v[172:175], v214 offset:9856
    s_mov_b64 exec, -1
    v_exp_f32 v22, v22
    v_exp_f32 v23, v23
    v_exp_f32 v24, v24
    v_exp_f32 v25, v25
    v_exp_f32 v26, v26
    v_exp_f32 v27, v27
    v_exp_f32 v28, v28
    v_exp_f32 v29, v29
    v_smfmac_f32_32x32x32_bf16 v[176:191], v[160:163], v[16:23], v211
    s_cmp_lg_u32 s30, 0
    s_cbranch_scc1 B_nox
    buffer_load_dwordx4 v[108:111], v1, s[4:7], 0 offen
    buffer_load_dwordx4 v[112:115], v1, s[4:7], 0 offen offset:16
    buffer_load_dwordx2 v[116:117], v1, s[4:7], 0 offen offset:32
    buffer_load_dwordx4 v[118:121], v218, s[48:51], 0 offen
    buffer_load_dwordx4 v[122:125], v218, s[48:51], 0 offen offset:16
    buffer_load_dwordx2 v[126:127], v218, s[48:51], 0 offen offset:32
    s_add_u32 s42, s39, 10240
    buffer_load_dword v10, v9, s[16:19], s42 offen sc1
B_nox:
    v_exp_f32 v30, v30
    v_exp_f32 v31, v31
    v_exp_f32 v32, v32
    v_exp_f32 v33, v33
    v_smfmac_f32_32x32x32_bf16 v[176:191], v[164:167], v[24:31], v211
    v_exp_f32 v34, v34
    v_exp_f32 v35, v35
    v_exp_f32 v36, v36
    v_exp_f32 v37, v37
    v_mfma_f32_32x32x16_bf16 v[48:63], v[102:105], v[80:83], v[48:63]
    v_exp_f32 v38, v38
    v_exp_f32 v39, v39
    v_exp_f32 v40, v40
    v_exp_f32 v41, v41
    v_mfma_f32_32x32x16_bf16 v[64:79], v[102:105], v[84:87], v[64:79]
    v_exp_f32 v42, v42
    v_exp_f32 v43, v43
    v_exp_f32 v44, v44
    v_exp_f32 v45, v45
    v_smfmac_f32_32x32x32_bf16 v[192:207], v[160:163], v[32:39], v211
    v_exp_f32 v46, v46
    v_exp_f32 v47, v47
    v_exp_f32 v48, v48
    v_exp_f32 v49, v49
    v_smfmac_f32_32x32x32_bf16 v[192:207], v[164:167], v[40:47], v211
    s_setprio 2
    s_waitcnt lgkmcnt(0)
    ds_read_b128 v[102:105], v213 offset:11520
    v_exp_f32 v50, v50
    v_exp_f32 v51, v51
    v_exp_f32 v52, v52
    v_exp_f32 v53, v53
    v_mfma_f32_32x32x4_2b_bf16 v[16:47], v[94:95], v[88:89], 0 cbsz:1 abid:1
    s_mov_b64 exec, s[44:45]
    ds_read_b128 v[160:163], v214 offset:11520
    ds_read_b128 v[164:167], v214 offset:12160
    s_mov_b64 exec, -1
    v_exp_f32 v54, v54
    v_exp_f32 v55, v55
    v_exp_f32 v56, v56
    v_exp_f32 v57, v57
    v_exp_f32 v58, v58
    v_exp_f32 v59, v59
    v_exp_f32 v60, v60
    v_exp_f32 v61, v61
    v_smfmac_f32_32x32x32_bf16 v[176:191], v[168:171], v[48:55], v211
    s_add_u32 m0, s38, 92160
    s_add_u32 s42, s37, 737280
    buffer_load_dwordx4 v212, s[8:11], s42 offen lds
    v_exp_f32 v62, v62
    v_exp_f32 v63, v63
    v_exp_f32 v64, v64
    v_exp_f32 v65, v65
    v_smfmac_f32_32x32x32_bf16 v[176:191], v[172:175], v[56:63], v211
    buffer_load_dword v11, v238, s[12:15], 0 offen offset:128 sc1
    v_exp_f32 v66, v66
    v_exp_f32 v67, v67
    v_exp_f32 v68, v68
    v_exp_f32 v69, v69
    v_mfma_f32_32x32x16_bf16 v[16:31], v[98:101], v[80:83], v[16:31]
    v_exp_f32 v70, v70
    v_exp_f32 v71, v71
    v_exp_f32 v72, v72
    v_exp_f32 v73, v73
    v_mfma_f32_32x32x16_bf16 v[32:47], v[98:101], v[84:87], v[32:47]
    v_exp_f32 v74, v74
    v_exp_f32 v75, v75
    v_exp_f32 v76, v76
    v_exp_f32 v77, v77
    v_smfmac_f32_32x32x32_bf16 v[192:207], v[168:171], v[64:71], v211
    v_exp_f32 v78, v78
    v_exp_f32 v79, v79
    v_exp_f32 v16, v16
    v_exp_f32 v17, v17
    v_smfmac_f32_32x32x32_bf16 v[192:207], v[172:175], v[72:79], v211
    s_setprio 1
    s_waitcnt lgkmcnt(0)
    v_exp_f32 v18, v18
    v_exp_f32 v19, v19
    v_exp_f32 v20, v20
    v_exp_f32 v21, v21
    v_mfma_f32_32x32x4_2b_bf16 v[48:79], v[96:97], v[88:89], 0 cbsz:1 abid:0
    s_mov_b64 exec, s[44:45]
    ds_read_b128 v[168:171], v214 offset:13824
    ds_read_b128 v[172:175], v214 offset:14464
    s_mov_b64 exec, -1
    v_exp_f32 v22, v22
    v_exp_f32 v23, v23
    v_exp_f32 v24, v24
    v_exp_f32 v25, v25
    v_exp_f32 v26, v26
    v_exp_f32 v27, v27
    v_exp_f32 v28, v28
    v_exp_f32 v29, v29
    v_smfmac_f32_32x32x32_bf16 v[176:191], v[160:163], v[16:23], v211
    v_exp_f32 v30, v30
    v_exp_f32 v31, v31
    v_exp_f32 v32, v32
    v_exp_f32 v33, v33
    v_smfmac_f32_32x32x32_bf16 v[176:191], v[164:167], v[24:31], v211
    v_exp_f32 v34, v34
    v_exp_f32 v35, v35
    v_exp_f32 v36, v36
    v_exp_f32 v37, v37
    v_mfma_f32_32x32x16_bf16 v[48:63], v[102:105], v[80:83], v[48:63]
    s_mul_i32 s43, s20, 60
    s_sub_u32 s43, 160, s43
    v_cmp_gt_i32 vcc, s43, v0
    s_and_b64 exec, exec, vcc
    s_cbranch_execz B_nwl
    s_add_u32 m0, s38, 99840
    s_add_u32 s42, s37, 798720
    buffer_load_dwordx4 v212, s[8:11], s42 offen lds
B_nwl:
    s_mov_b64 exec, -1
    v_exp_f32 v38, v38
    v_exp_f32 v39, v39
    v_exp_f32 v40, v40
    v_exp_f32 v41, v41
    v_mfma_f32_32x32x16_bf16 v[64:79], v[102:105], v[84:87], v[64:79]
    v_exp_f32 v42, v42
    v_exp_f32 v43, v43
    v_exp_f32 v44, v44
    v_exp_f32 v45, v45
    v_smfmac_f32_32x32x32_bf16 v[192:207], v[160:163], v[32:39], v211
    v_exp_f32 v46, v46
    v_exp_f32 v47, v47
    v_exp_f32 v48, v48
    v_exp_f32 v49, v49
    v_smfmac_f32_32x32x32_bf16 v[192:207], v[164:167], v[40:47], v211
    s_setprio 0
    s_waitcnt lgkmcnt(0)
    v_exp_f32 v50, v50
    v_exp_f32 v51, v51
    v_exp_f32 v52, v52
    v_exp_f32 v53, v53
    v_exp_f32 v54, v54
    v_exp_f32 v55, v55
    v_exp_f32 v56, v56
    v_exp_f32 v57, v57
    v_exp_f32 v58, v58
    v_exp_f32 v59, v59
    v_exp_f32 v60, v60
    v_exp_f32 v61, v61
    v_smfmac_f32_32x32x32_bf16 v[176:191], v[168:171], v[48:55], v211
    s_waitcnt vmcnt(0)
C_chk:
    v_cmp_eq_u32 vcc, 0, v11
    s_cbranch_vccnz C_again
C_chkd:
    v_exp_f32 v62, v62
    v_exp_f32 v63, v63
    v_exp_f32 v64, v64
    v_exp_f32 v65, v65
    v_smfmac_f32_32x32x32_bf16 v[176:191], v[172:175], v[56:63], v211
    s_add_u32 s40, s40, s30
    s_and_b32 s42, s40, 7
    s_mul_i32 s42, s42, 1280
    s_add_u32 s42, s42, s39
    s_mov_b32 s46, 0x12800000
    s_mov_b32 s47, 0x6c800000
    v_exp_f32 v66, v66
    v_exp_f32 v67, v67
    v_exp_f32 v68, v68
    v_exp_f32 v69, v69
    v_exp_f32 v70, v70
    v_exp_f32 v71, v71
    v_exp_f32 v72, v72
    v_exp_f32 v73, v73
    v_exp_f32 v74, v74
    v_exp_f32 v75, v75
    v_exp_f32 v76, v76
    v_exp_f32 v77, v77
    v_smfmac_f32_32x32x32_bf16 v[192:207], v[168:171], v[64:71], v211
    ds_write_b128 v223, v[176:179]
    ds_write_b128 v223, v[180:183] offset:1024
    ds_write_b64 v224, v[184:185] offset:2176
    ds_write_b32 v229, v186 offset:2048
    v_exp_f32 v78, v78
    v_exp_f32 v79, v79
    s_nop 1
    v_smfmac_f32_32x32x32_bf16 v[192:207], v[172:175], v[72:79], v211
    s_waitcnt lgkmcnt(0)
    s_barrier
    ds_read_b32 v26, v230 offset:2048
    ds_read_b128 v[16:19], v225
    ds_read_b128 v[20:23], v225 offset:1024
    ds_read_b64 v[24:25], v226 offset:2176
    s_waitcnt lgkmcnt(3)
    s_nop 4
    v_add_f32 v13, v26, v202
    v_cmp_nle_f32 vcc, s46, v13
    v_cmp_nge_f32 s[46:47], s47, v13
    v_rcp_f32 v12, v13
    s_or_b64 vcc, vcc, s[46:47]
    s_waitcnt lgkmcnt(0)
    v_pk_add_f32 v[192:193], v[192:193], v[16:17]
    v_pk_add_f32 v[194:195], v[194:195], v[18:19]
    v_pk_add_f32 v[196:197], v[196:197], v[20:21]
    v_pk_add_f32 v[198:199], v[198:199], v[22:23]
    v_pk_add_f32 v[200:201], v[200:201], v[24:25]
    s_cbranch_vccnz B_fallback
B_fin:
    v_pk_mul_f32 v[192:193], v[192:193], v[12:13] op_sel_hi:[1,0]
    v_pk_mul_f32 v[194:195], v[194:195], v[12:13] op_sel_hi:[1,0]
    v_pk_mul_f32 v[196:197], v[196:197], v[12:13] op_sel_hi:[1,0]
    v_pk_mul_f32 v[198:199], v[198:199], v[12:13] op_sel_hi:[1,0]
    v_pk_mul_f32 v[200:201], v[200:201], v[12:13] op_sel_hi:[1,0]
    v_cvt_pk_bf16_f32 v96, v192, v193
    v_cvt_pk_bf16_f32 v97, v194, v195
    v_cvt_pk_bf16_f32 v98, v196, v197
    v_cvt_pk_bf16_f32 v99, v198, v199
    v_cvt_pk_bf16_f32 v100, v200, v201
    v_max_i32 v96, 0x80000001, v96
    v_max_i32 v97, 0x80000001, v97
    v_max_i32 v98, 0x80000001, v98
    v_max_i32 v99, 0x80000001, v99
    v_max_i32 v100, 0x80000001, v100
    buffer_store_dwordx4 v[96:99], v9, s[16:19], s42 offen sc1
    buffer_store_dword v100, v228, s[16:19], s42 offen offset:1024 sc1
    ds_read_b64_tr_b16 v[56:57], v252 offset:0
    ds_read_b64_tr_b16 v[58:59], v252 offset:1280
    ds_read_b64_tr_b16 v[60:61], v252 offset:8
    ds_read_b64_tr_b16 v[62:63], v252 offset:1288
    ds_read_b64_tr_b16 v[64:65], v252 offset:16
    ds_read_b64_tr_b16 v[66:67], v252 offset:1296
    ds_read_b64_tr_b16 v[68:69], v252 offset:24
    ds_read_b64_tr_b16 v[70:71], v252 offset:1304
    ds_read_b64_tr_b16 v[72:73], v252 offset:32
    ds_read_b64_tr_b16 v[74:75], v252 offset:1312
    ds_read_b64_tr_b16 v[76:77], v252 offset:6400
    ds_read_b64_tr_b16 v[78:79], v252 offset:7680
    ds_read_b64_tr_b16 v[80:81], v252 offset:6408
    ds_read_b64_tr_b16 v[82:83], v252 offset:7688
    ds_read_b64_tr_b16 v[84:85], v252 offset:6416
    ds_read_b64_tr_b16 v[86:87], v252 offset:7696
    ds_read_b64_tr_b16 v[88:89], v252 offset:6424
    ds_read_b64_tr_b16 v[90:91], v252 offset:7704
    ds_read_b64_tr_b16 v[92:93], v252 offset:6432
    ds_read_b64_tr_b16 v[94:95], v252 offset:7712
    ds_read_b64_tr_b16 v[160:161], v252 offset:12800
    ds_read_b64_tr_b16 v[162:163], v252 offset:14080
    ds_read_b64_tr_b16 v[164:165], v252 offset:12808
    ds_read_b64_tr_b16 v[166:167], v252 offset:14088
    ds_read_b64_tr_b16 v[168:169], v252 offset:12816
    ds_read_b64_tr_b16 v[170:171], v252 offset:14096
    ds_read_b64_tr_b16 v[172:173], v252 offset:12824
    ds_read_b64_tr_b16 v[174:175], v252 offset:14104
    ds_read_b64_tr_b16 v[176:177], v252 offset:12832
    ds_read_b64_tr_b16 v[178:179], v252 offset:14112
    ds_read_b64_tr_b16 v[180:181], v252 offset:19200
    ds_read_b64_tr_b16 v[182:183], v252 offset:20480
    ds_read_b64_tr_b16 v[184:185], v252 offset:19208
    ds_read_b64_tr_b16 v[186:187], v252 offset:20488
    ds_read_b64_tr_b16 v[188:189], v252 offset:19216
    ds_read_b64_tr_b16 v[190:191], v252 offset:20496
    ds_read_b64_tr_b16 v[192:193], v252 offset:19224
    ds_read_b64_tr_b16 v[194:195], v252 offset:20504
    ds_read_b64_tr_b16 v[196:197], v252 offset:19232
    ds_read_b64_tr_b16 v[198:199], v252 offset:20512
    ds_read_b64_tr_b16 v[16:17], v253 offset:0
    ds_read_b64_tr_b16 v[18:19], v253 offset:3200
    ds_read_b64_tr_b16 v[20:21], v253 offset:8
    ds_read_b64_tr_b16 v[22:23], v253 offset:3208
    ds_read_b64_tr_b16 v[24:25], v253 offset:16
    ds_read_b64_tr_b16 v[26:27], v253 offset:3216
    ds_read_b64_tr_b16 v[28:29], v253 offset:24
    ds_read_b64_tr_b16 v[30:31], v253 offset:3224
    ds_read_b64_tr_b16 v[32:33], v253 offset:32
    ds_read_b64_tr_b16 v[34:35], v253 offset:3232
    ds_read_b64_tr_b16 v[36:37], v253 offset:25600
    ds_read_b64_tr_b16 v[38:39], v253 offset:28800
    ds_read_b64_tr_b16 v[40:41], v253 offset:25608
    ds_read_b64_tr_b16 v[42:43], v253 offset:28808
    ds_read_b64_tr_b16 v[44:45], v253 offset:25616
    ds_read_b64_tr_b16 v[46:47], v253 offset:28816
    ds_read_b64_tr_b16 v[48:49], v253 offset:25624
    ds_read_b64_tr_b16 v[50:51], v253 offset:28824
    ds_read_b64_tr_b16 v[52:53], v253 offset:25632
    ds_read_b64_tr_b16 v[54:55], v253 offset:28832
    s_bitcmp1_b32 s22, 0
    s_cselect_b32 s42, -1, 1
    s_mul_i32 s43, s42, 25600
    v_add_u32 v12, s43, v252
    s_mul_i32 s43, s42, 917504
    v_add_u32 v13, s43, v254
    s_mov_b32 s43, 7864320
    buffer_load_dwordx4 v[200:203], v254, s[16:19], s43 offen sc1
    s_mov_b32 s43, 8093696
    buffer_load_dwordx4 v[204:207], v254, s[16:19], s43 offen sc1
    s_mov_b32 s43, 8323072
    buffer_load_dwordx4 v[208:211], v254, s[16:19], s43 offen sc1
    s_mov_b32 s43, 8552448
    buffer_load_dwordx4 v[212:215], v254, s[16:19], s43 offen sc1
    s_mov_b32 s43, 7864320
    buffer_load_dwordx2 v[152:153], v255, s[16:19], s43 offen offset:1024 sc1
    s_mov_b32 s43, 7979008
    buffer_load_dwordx2 v[154:155], v255, s[16:19], s43 offen offset:1024 sc1
    s_mov_b32 s43, 8781824
    buffer_load_dwordx2 v[156:157], v255, s[16:19], s43 offen offset:1024 sc1
    s_mov_b32 s43, 8896512
    buffer_load_dwordx2 v[158:159], v255, s[16:19], s43 offen offset:1024 sc1
    s_mov_b32 s43, 7864320
    buffer_load_dwordx4 v[216:219], v13, s[16:19], s43 offen sc1
    s_mov_b32 s43, 8093696
    buffer_load_dwordx4 v[220:223], v13, s[16:19], s43 offen sc1
    s_mov_b32 s43, 8323072
    buffer_load_dwordx4 v[224:227], v13, s[16:19], s43 offen sc1
    s_mov_b32 s43, 8552448
    buffer_load_dwordx4 v[228:231], v13, s[16:19], s43 offen sc1
    s_mul_i32 s43, s31, 2304
    s_add_u32 s43, s43, 123008
    v_add_u32 v10, s43, v9
    s_lshr_b32 s43, s31, 1
    s_mul_i32 s43, s43, 18432
    s_and_b32 s46, s31, 1
    s_mul_i32 s46, s46, 3072
    s_add_u32 s43, s43, s46
    s_add_u32 s43, s43, 132224
    v_add_u32 v14, s43, v9
    s_mov_b32 s41, 0x80000001
    v_mov_b32 v232, 0
    v_mov_b32 v233, 0
    v_mov_b32 v234, 0
    v_mov_b32 v235, 0
    v_mov_b32 v236, 0
    v_mov_b32 v237, 0
    v_mov_b32 v238, 0
    v_mov_b32 v239, 0
    v_mov_b32 v240, 0
    v_mov_b32 v241, 0
    v_mov_b32 v242, 0
    v_mov_b32 v243, 0
    v_mov_b32 v244, 0
    v_mov_b32 v245, 0
    v_mov_b32 v246, 0
    v_mov_b32 v247, 0
    v_mov_b32 v248, 0
    v_mov_b32 v249, 0
    v_mov_b32 v250, 0
    v_mov_b32 v251, 0
    s_mov_b32 s47, 262144
    s_waitcnt vmcnt(11) lgkmcnt(0)
    v_min3_i32 v4, v200, v201, v202
    v_min_i32 v4, v4, v203
    v_cmp_gt_i32 vcc, s41, v4
    s_movk_i32 s46, 1023
    s_cbranch_vccnz C_SK0
    v_mfma_f32_16x16x32_bf16 v[232:235], v[56:59], v[200:203], v[232:235]
    ds_read_b64_tr_b16 v[56:57], v12 offset:0
    ds_read_b64_tr_b16 v[58:59], v12 offset:1280
    s_waitcnt vmcnt(10)
    v_min3_i32 v4, v204, v205, v206
    v_min_i32 v4, v4, v207
    v_cmp_gt_i32 vcc, s41, v4
    v_mfma_f32_16x16x32_bf16 v[236:239], v[60:63], v[200:203], v[236:239]
    ds_read_b64_tr_b16 v[60:61], v12 offset:8
    ds_read_b64_tr_b16 v[62:63], v12 offset:1288
    v_mfma_f32_16x16x32_bf16 v[240:243], v[64:67], v[200:203], v[240:243]
    ds_read_b64_tr_b16 v[64:65], v12 offset:16
    ds_read_b64_tr_b16 v[66:67], v12 offset:1296
    v_mfma_f32_16x16x32_bf16 v[244:247], v[68:71], v[200:203], v[244:247]
    ds_read_b64_tr_b16 v[68:69], v12 offset:24
    ds_read_b64_tr_b16 v[70:71], v12 offset:1304
    v_mfma_f32_16x16x32_bf16 v[248:251], v[72:75], v[200:203], v[248:251]
    ds_read_b64_tr_b16 v[72:73], v12 offset:32
    ds_read_b64_tr_b16 v[74:75], v12 offset:1312
    s_movk_i32 s46, 1022
    s_cbranch_vccnz C_SK1
    v_mfma_f32_16x16x32_bf16 v[232:235], v[76:79], v[204:207], v[232:235]
    ds_read_b64_tr_b16 v[76:77], v12 offset:6400
    ds_read_b64_tr_b16 v[78:79], v12 offset:7680
    s_waitcnt vmcnt(9)
    v_min3_i32 v4, v208, v209, v210
    v_min_i32 v4, v4, v211
    v_cmp_gt_i32 vcc, s41, v4
    v_mfma_f32_16x16x32_bf16 v[236:239], v[80:83], v[204:207], v[236:239]
    ds_read_b64_tr_b16 v[80:81], v12 offset:6408
    ds_read_b64_tr_b16 v[82:83], v12 offset:7688
    v_mfma_f32_16x16x32_bf16 v[240:243], v[84:87], v[204:207], v[240:243]
    ds_read_b64_tr_b16 v[84:85], v12 offset:6416
    ds_read_b64_tr_b16 v[86:87], v12 offset:7696
    v_mfma_f32_16x16x32_bf16 v[244:247], v[88:91], v[204:207], v[244:247]
    ds_read_b64_tr_b16 v[88:89], v12 offset:6424
    ds_read_b64_tr_b16 v[90:91], v12 offset:7704
    v_mfma_f32_16x16x32_bf16 v[248:251], v[92:95], v[204:207], v[248:251]
    ds_read_b64_tr_b16 v[92:93], v12 offset:6432
    ds_read_b64_tr_b16 v[94:95], v12 offset:7712
    s_movk_i32 s46, 1020
    s_cbranch_vccnz C_SK2
    v_mfma_f32_16x16x32_bf16 v[232:235], v[160:163], v[208:211], v[232:235]
    ds_read_b64_tr_b16 v[160:161], v12 offset:12800
    ds_read_b64_tr_b16 v[162:163], v12 offset:14080
    s_waitcnt vmcnt(8)
    v_min3_i32 v4, v212, v213, v214
    v_min_i32 v4, v4, v215
    v_cmp_gt_i32 vcc, s41, v4
    v_mfma_f32_16x16x32_bf16 v[236:239], v[164:167], v[208:211], v[236:239]
    ds_read_b64_tr_b16 v[164:165], v12 offset:12808
    ds_read_b64_tr_b16 v[166:167], v12 offset:14088
    v_mfma_f32_16x16x32_bf16 v[240:243], v[168:171], v[208:211], v[240:243]
    ds_read_b64_tr_b16 v[168:169], v12 offset:12816
    ds_read_b64_tr_b16 v[170:171], v12 offset:14096
    v_mfma_f32_16x16x32_bf16 v[244:247], v[172:175], v[208:211], v[244:247]
    ds_read_b64_tr_b16 v[172:173], v12 offset:12824
    ds_read_b64_tr_b16 v[174:175], v12 offset:14104
    v_mfma_f32_16x16x32_bf16 v[248:251], v[176:179], v[208:211], v[248:251]
    ds_read_b64_tr_b16 v[176:177], v12 offset:12832
    ds_read_b64_tr_b16 v[178:179], v12 offset:14112
    s_movk_i32 s46, 1016
    s_cbranch_vccnz C_SK3
    v_mfma_f32_16x16x32_bf16 v[232:235], v[180:183], v[212:215], v[232:235]
    ds_read_b64_tr_b16 v[180:181], v12 offset:19200
    ds_read_b64_tr_b16 v[182:183], v12 offset:20480
    s_waitcnt vmcnt(6)
    v_min3_i32 v4, v152, v153, v154
    v_min_i32 v4, v4, v155
    v_cmp_gt_i32 vcc, s41, v4
    v_mfma_f32_16x16x32_bf16 v[236:239], v[184:187], v[212:215], v[236:239]
    ds_read_b64_tr_b16 v[184:185], v12 offset:19208
    ds_read_b64_tr_b16 v[186:187], v12 offset:20488
    v_mfma_f32_16x16x32_bf16 v[240:243], v[188:191], v[212:215], v[240:243]
    ds_read_b64_tr_b16 v[188:189], v12 offset:19216
    ds_read_b64_tr_b16 v[190:191], v12 offset:20496
    v_mfma_f32_16x16x32_bf16 v[244:247], v[192:195], v[212:215], v[244:247]
    ds_read_b64_tr_b16 v[192:193], v12 offset:19224
    ds_read_b64_tr_b16 v[194:195], v12 offset:20504
    v_mfma_f32_16x16x32_bf16 v[248:251], v[196:199], v[212:215], v[248:251]
    ds_read_b64_tr_b16 v[196:197], v12 offset:19232
    ds_read_b64_tr_b16 v[198:199], v12 offset:20512
    s_movk_i32 s46, 1008
    s_cbranch_vccnz C_SK8
    v_mfma_f32_16x16x32_bf16 v[232:235], v[16:19], v[152:155], v[232:235]
    s_waitcnt vmcnt(4)
    v_min3_i32 v4, v156, v157, v158
    v_min_i32 v4, v4, v159
    v_cmp_gt_i32 vcc, s41, v4
    v_mfma_f32_16x16x32_bf16 v[236:239], v[20:23], v[152:155], v[236:239]
    v_mfma_f32_16x16x32_bf16 v[240:243], v[24:27], v[152:155], v[240:243]
    v_mfma_f32_16x16x32_bf16 v[244:247], v[28:31], v[152:155], v[244:247]
    v_mfma_f32_16x16x32_bf16 v[248:251], v[32:35], v[152:155], v[248:251]
    s_movk_i32 s46, 752
    s_cbranch_vccnz C_SK9
    v_mfma_f32_16x16x32_bf16 v[232:235], v[36:39], v[156:159], v[232:235]
    s_waitcnt vmcnt(3)
    v_min3_i32 v4, v216, v217, v218
    v_min_i32 v4, v4, v219
    v_cmp_gt_i32 vcc, s41, v4
    v_mfma_f32_16x16x32_bf16 v[236:239], v[40:43], v[156:159], v[236:239]
    v_mfma_f32_16x16x32_bf16 v[240:243], v[44:47], v[156:159], v[240:243]
    v_mfma_f32_16x16x32_bf16 v[244:247], v[48:51], v[156:159], v[244:247]
    v_mfma_f32_16x16x32_bf16 v[248:251], v[52:55], v[156:159], v[248:251]
    s_movk_i32 s46, 240
    s_cbranch_vccnz C_SK4
    s_waitcnt lgkmcnt(0)
    v_mfma_f32_16x16x32_bf16 v[232:235], v[56:59], v[216:219], v[232:235]
    s_waitcnt vmcnt(2)
    v_min3_i32 v4, v220, v221, v222
    v_min_i32 v4, v4, v223
    v_cmp_gt_i32 vcc, s41, v4
    v_mfma_f32_16x16x32_bf16 v[236:239], v[60:63], v[216:219], v[236:239]
    v_mfma_f32_16x16x32_bf16 v[240:243], v[64:67], v[216:219], v[240:243]
    v_mfma_f32_16x16x32_bf16 v[244:247], v[68:71], v[216:219], v[244:247]
    v_mfma_f32_16x16x32_bf16 v[248:251], v[72:75], v[216:219], v[248:251]
    s_movk_i32 s46, 224
    s_cbranch_vccnz C_SK5
    v_mfma_f32_16x16x32_bf16 v[232:235], v[76:79], v[220:223], v[232:235]
    s_waitcnt vmcnt(1)
    v_min3_i32 v4, v224, v225, v226
    v_min_i32 v4, v4, v227
    v_cmp_gt_i32 vcc, s41, v4
    v_mfma_f32_16x16x32_bf16 v[236:239], v[80:83], v[220:223], v[236:239]
    v_mfma_f32_16x16x32_bf16 v[240:243], v[84:87], v[220:223], v[240:243]
    v_mfma_f32_16x16x32_bf16 v[244:247], v[88:91], v[220:223], v[244:247]
    v_mfma_f32_16x16x32_bf16 v[248:251], v[92:95], v[220:223], v[248:251]
    s_movk_i32 s46, 192
    s_cbranch_vccnz C_SK6
    v_mfma_f32_16x16x32_bf16 v[232:235], v[160:163], v[224:227], v[232:235]
    s_waitcnt vmcnt(0)
    v_min3_i32 v4, v228, v229, v230
    v_min_i32 v4, v4, v231
    v_cmp_gt_i32 vcc, s41, v4
    v_mfma_f32_16x16x32_bf16 v[236:239], v[164:167], v[224:227], v[236:239]
    v_mfma_f32_16x16x32_bf16 v[240:243], v[168:171], v[224:227], v[240:243]
    v_mfma_f32_16x16x32_bf16 v[244:247], v[172:175], v[224:227], v[244:247]
    v_mfma_f32_16x16x32_bf16 v[248:251], v[176:179], v[224:227], v[248:251]
    s_movk_i32 s46, 128
    s_cbranch_vccnz C_SK7
    v_mfma_f32_16x16x32_bf16 v[232:235], v[180:183], v[228:231], v[232:235]
    v_mfma_f32_16x16x32_bf16 v[236:239], v[184:187], v[228:231], v[236:239]
    v_mfma_f32_16x16x32_bf16 v[240:243], v[188:191], v[228:231], v[240:243]
    v_mfma_f32_16x16x32_bf16 v[244:247], v[192:195], v[228:231], v[244:247]
    v_mfma_f32_16x16x32_bf16 v[248:251], v[196:199], v[228:231], v[248:251]
C_full:
    s_cmp_eq_u32 s30, 0
    s_cbranch_scc1 C_main
    s_nop 1
    ds_write_b128 v10, v[232:235] offset:0
    ds_write_b128 v10, v[236:239] offset:1024
    ds_write_b128 v14, v[240:243] offset:0
    ds_write_b128 v14, v[244:247] offset:1024
    ds_write_b128 v14, v[248:251] offset:2048
    s_waitcnt lgkmcnt(0)
    s_barrier
    s_branch D_helper
C_main:
    s_mov_b32 s46, 0xffff0000
    v_mov_b32 v23, 0
    v_mov_b32 v40, 0x3f803f80
    v_lshlrev_b32 v60, 16, v108
    v_and_b32 v61, s46, v108
    v_add_f32 v232, v232, v60
    v_add_f32 v233, v233, v61
    v_lshlrev_b32 v60, 16, v109
    v_and_b32 v61, s46, v109
    v_add_f32 v234, v234, v60
    v_add_f32 v235, v235, v61
    v_lshlrev_b32 v60, 16, v110
    v_and_b32 v61, s46, v110
    v_add_f32 v236, v236, v60
    v_add_f32 v237, v237, v61
    v_lshlrev_b32 v60, 16, v111
    v_and_b32 v61, s46, v111
    v_add_f32 v238, v238, v60
    v_add_f32 v239, v239, v61
    v_lshlrev_b32 v60, 16, v112
    v_and_b32 v61, s46, v112
    v_add_f32 v240, v240, v60
    v_add_f32 v241, v241, v61
    v_lshlrev_b32 v60, 16, v113
    v_and_b32 v61, s46, v113
    v_add_f32 v242, v242, v60
    v_add_f32 v243, v243, v61
    v_lshlrev_b32 v60, 16, v114
    v_and_b32 v61, s46, v114
    v_add_f32 v244, v244, v60
    v_add_f32 v245, v245, v61
    v_lshlrev_b32 v60, 16, v115
    v_and_b32 v61, s46, v115
    v_add_f32 v246, v246, v60
    v_add_f32 v247, v247, v61
    v_lshlrev_b32 v60, 16, v116
    v_and_b32 v61, s46, v116
    v_add_f32 v248, v248, v60
    v_add_f32 v249, v249, v61
    v_lshlrev_b32 v60, 16, v117
    v_and_b32 v61, s46, v117
    v_add_f32 v250, v250, v60
    v_add_f32 v251, v251, v61
    v_dot2c_f32_bf16 v23, v118, v40
    v_dot2c_f32_bf16 v23, v119, v40
    v_dot2c_f32_bf16 v23, v120, v40
    v_dot2c_f32_bf16 v23, v121, v40
    v_dot2c_f32_bf16 v23, v122, v40
    v_dot2c_f32_bf16 v23, v123, v40
    v_dot2c_f32_bf16 v23, v124, v40
    v_dot2c_f32_bf16 v23, v125, v40
    v_dot2c_f32_bf16 v23, v126, v40
    v_dot2c_f32_bf16 v23, v127, v40
    v_mov_b32 v20, 0
    v_mov_b32 v21, 0
    v_mov_b32 v22, 0
    s_barrier
    ds_read_b128 v[64:67], v10 offset:0
    ds_read_b128 v[68:71], v10 offset:1024
    ds_read_b128 v[72:75], v14 offset:0
    ds_read_b128 v[76:79], v14 offset:1024
    ds_read_b128 v[80:83], v14 offset:2048
    s_waitcnt lgkmcnt(4)
    v_pk_add_f32 v[232:233], v[232:233], v[64:65]
    v_cvt_pk_bf16_f32 v108, v232, v233
    v_dot2c_f32_bf16 v20, v108, v40
    v_dot2c_f32_bf16 v21, v108, v108
    v_dot2c_f32_bf16 v22, v108, v118
    v_pk_add_f32 v[234:235], v[234:235], v[66:67]
    v_cvt_pk_bf16_f32 v109, v234, v235
    v_dot2c_f32_bf16 v20, v109, v40
    v_dot2c_f32_bf16 v21, v109, v109
    v_dot2c_f32_bf16 v22, v109, v119
    s_waitcnt lgkmcnt(3)
    v_pk_add_f32 v[236:237], v[236:237], v[68:69]
    v_cvt_pk_bf16_f32 v110, v236, v237
    v_dot2c_f32_bf16 v20, v110, v40
    v_dot2c_f32_bf16 v21, v110, v110
    v_dot2c_f32_bf16 v22, v110, v120
    v_pk_add_f32 v[238:239], v[238:239], v[70:71]
    v_cvt_pk_bf16_f32 v111, v238, v239
    v_dot2c_f32_bf16 v20, v111, v40
    v_dot2c_f32_bf16 v21, v111, v111
    v_dot2c_f32_bf16 v22, v111, v121
    s_waitcnt lgkmcnt(2)
    v_pk_add_f32 v[240:241], v[240:241], v[72:73]
    v_cvt_pk_bf16_f32 v112, v240, v241
    v_dot2c_f32_bf16 v20, v112, v40
    v_dot2c_f32_bf16 v21, v112, v112
    v_dot2c_f32_bf16 v22, v112, v122
    v_pk_add_f32 v[242:243], v[242:243], v[74:75]
    v_cvt_pk_bf16_f32 v113, v242, v243
    v_dot2c_f32_bf16 v20, v113, v40
    v_dot2c_f32_bf16 v21, v113, v113
    v_dot2c_f32_bf16 v22, v113, v123
    s_waitcnt lgkmcnt(1)
    v_pk_add_f32 v[244:245], v[244:245], v[76:77]
    v_cvt_pk_bf16_f32 v114, v244, v245
    v_dot2c_f32_bf16 v20, v114, v40
    v_dot2c_f32_bf16 v21, v114, v114
    v_dot2c_f32_bf16 v22, v114, v124
    v_pk_add_f32 v[246:247], v[246:247], v[78:79]
    v_cvt_pk_bf16_f32 v115, v246, v247
    v_dot2c_f32_bf16 v20, v115, v40
    v_dot2c_f32_bf16 v21, v115, v115
    v_dot2c_f32_bf16 v22, v115, v125
    s_waitcnt lgkmcnt(0)
    v_pk_add_f32 v[248:249], v[248:249], v[80:81]
    v_cvt_pk_bf16_f32 v116, v248, v249
    v_dot2c_f32_bf16 v20, v116, v40
    v_dot2c_f32_bf16 v21, v116, v116
    v_dot2c_f32_bf16 v22, v116, v126
    v_pk_add_f32 v[250:251], v[250:251], v[82:83]
    v_cvt_pk_bf16_f32 v117, v250, v251
    v_dot2c_f32_bf16 v20, v117, v40
    v_dot2c_f32_bf16 v21, v117, v117
    v_dot2c_f32_bf16 v22, v117, v127
    v_lshlrev_b32 v2, 4, v7
    v_lshl_add_u32 v3, v8, 2, v2
    s_nop 0
    v_permlane32_swap_b32 v20, v22
    v_permlane32_swap_b32 v21, v23
    v_add_f32 v20, v20, v22
    v_add_f32 v21, v21, v23
    s_lshl_b32 s42, s31, 8
    s_add_u32 s43, s42, s39
    v_permlane16_swap_b32 v20, v21
    v_add_f32 v20, v20, v21
    s_add_u32 s43, s43, 10240
    v_min_u32 v20, -2, v20
    s_cmp_eq_u32 s3, 0
    s_cbranch_scc1 C_slowst
    buffer_store_dword v20, v3, s[16:19], s43 offen
C_std:
    s_mul_i32 s43, s21, 114688
    s_add_u32 s43, s43, s42
    s_add_u32 s43, s43, 7874560
    s_add_u32 s41, s43, 14336
    v_mul_u32_u24 v4, 28672, v8
    v_add_u32 v4, v4, v2
    s_mov_b32 s47, 262144
    v_min_u32 v108, -2, v108
    v_min_u32 v109, -2, v109
    v_min_u32 v110, -2, v110
    v_min_u32 v111, -2, v111
    v_min_u32 v112, -2, v112
    v_min_u32 v113, -2, v113
    v_min_u32 v114, -2, v114
    v_min_u32 v115, -2, v115
    v_min_u32 v116, -2, v116
    v_min_u32 v117, -2, v117
C_p1:
    buffer_load_dwordx4 v[24:27], v4, s[16:19], s43 offen sc1
    buffer_load_dwordx4 v[28:31], v4, s[16:19], s41 offen sc1
    s_sub_u32 s47, s47, 1
    s_cbranch_scc1 C_p1d
    s_waitcnt vmcnt(0)
    v_max3_u32 v5, v24, v25, v26
    v_max3_u32 v5, v5, v27, v28
    v_max3_u32 v5, v5, v29, v30
    v_max_u32 v5, v5, v31
    v_cmp_eq_u32 vcc, -1, v5
    s_cbranch_vccnz C_p1
C_p1d:
    s_waitcnt vmcnt(0)
    v_pk_add_f32 v[24:25], v[24:25], v[28:29]
    v_pk_add_f32 v[26:27], v[26:27], v[30:31]
    v_mov_b32 v28, v24
    v_mov_b32 v29, v25
    v_mov_b32 v30, v26
    v_mov_b32 v31, v27
    v_permlane16_swap_b32 v28, v24
    v_permlane16_swap_b32 v29, v25
    v_permlane16_swap_b32 v30, v26
    v_permlane16_swap_b32 v31, v27
    v_pk_add_f32 v[24:25], v[24:25], v[28:29]
    v_pk_add_f32 v[26:27], v[26:27], v[30:31]
    v_mov_b32 v28, v24
    v_mov_b32 v29, v25
    v_mov_b32 v30, v26
    v_mov_b32 v31, v27
    v_permlane32_swap_b32 v28, v24
    v_permlane32_swap_b32 v29, v25
    v_permlane32_swap_b32 v30, v26
    v_permlane32_swap_b32 v31, v27
    v_pk_add_f32 v[24:25], v[24:25], v[28:29]
    v_pk_add_f32 v[26:27], v[26:27], v[30:31]
    s_mov_b32 s41, 0x3acccccd
    v_mul_f32 v24, s41, v24
    v_mul_f32 v25, s41, v25
    v_fma_f32 v25, -v24, v24, v25
    v_max_f32 v25, 0, v25
    v_add_f32 v25, 0x3727c5ac, v25
    v_rsq_f32 v25, v25
    v_fma_f32 v26, -v24, v27, v26
    s_mov_b32 s41, 0xfffff800
    v_mul_f32 v26, v26, v25
    v_sub_u32 v5, 2047, v15
    v_ashrrev_i32 v28, 31, v26
    v_or_b32 v28, 0x80000000, v28
    v_xor_b32 v28, v28, v26
    v_min_u32 v28, 0xfffff7ff, v28
    v_and_or_b32 v28, v28, s41, v5
    v_mov_b32 v30, v28
    v_mov_b32 v31, 0
    s_nop 0
    v_mov_b32_dpp v5, v30 quad_perm:[1,0,3,2] row_mask:0xf bank_mask:0xf
    v_max_u32_dpp v31, v31, v31 quad_perm:[1,0,3,2] row_mask:0xf bank_mask:0xf
    v_med3_u32 v31, v30, v5, v31
    v_max_u32 v30, v30, v5
    s_nop 1
    v_mov_b32_dpp v5, v30 quad_perm:[2,3,0,1] row_mask:0xf bank_mask:0xf
    v_max_u32_dpp v31, v31, v31 quad_perm:[2,3,0,1] row_mask:0xf bank_mask:0xf
    v_med3_u32 v31, v30, v5, v31
    v_max_u32 v30, v30, v5
    s_nop 1
    v_mov_b32_dpp v5, v30 row_half_mirror row_mask:0xf bank_mask:0xf
    v_max_u32_dpp v31, v31, v31 row_half_mirror row_mask:0xf bank_mask:0xf
    v_med3_u32 v31, v30, v5, v31
    v_max_u32 v30, v30, v5
    s_nop 1
    v_mov_b32_dpp v5, v30 row_mirror row_mask:0xf bank_mask:0xf
    v_max_u32_dpp v31, v31, v31 row_mirror row_mask:0xf bank_mask:0xf
    v_med3_u32 v31, v30, v5, v31
    v_max_u32 v30, v30, v5
    s_cmp_lg_u32 s22, s31
    s_cbranch_scc1 C_nokey
    s_add_u32 s43, s39, 13312
    s_mov_b64 exec, 1
    buffer_store_dwordx2 v[30:31], off, s[16:19], s43 sc1
    s_mov_b64 exec, -1
C_nokey:
    v_mul_f32 v26, 0xbfb8aa3b, v26
    v_cmp_eq_u32 vcc, v28, v31
    v_exp_f32 v26, v26
    v_cmp_eq_u32 s[34:35], v28, v30
    v_cndmask_b32 v5, 0, 1, vcc
    v_add_f32 v26, 1.0, v26
    s_or_b64 s[34:35], s[34:35], vcc
    v_rcp_f32 v26, v26
    v_lshlrev_b32 v5, 8, v5
    v_lshl_add_u32 v6, v8, 3, v5
    v_lshl_add_u32 v4, v8, 4, v5
    v_min_u32 v32, -2, v24
    v_min_u32 v33, -2, v25
    v_min_u32 v34, -2, v26
    v_mov_b32 v35, 0
    s_lshl_b32 s43, s31, 9
    s_add_u32 s43, s43, s39
    s_add_u32 s43, s43, 11264
    s_mov_b64 exec, s[34:35]
    buffer_store_dwordx4 v[108:111], v4, s[16:19], s43 offen sc1
    buffer_store_dwordx4 v[112:115], v4, s[16:19], s43 offen offset:64 sc1
    buffer_store_dwordx2 v[116:117], v6, s[16:19], s43 offen offset:128 sc1
    s_and_b32 exec_lo, exec_lo, 0xffff
    s_mov_b32 exec_hi, 0
    buffer_store_dwordx4 v[32:35], v5, s[16:19], s43 offen offset:160 sc1
    s_mov_b64 exec, -1
    s_barrier
    v_mul_f32 v36, -v24, v25
    v_add_f32 v38, 1.0, v25
    v_lshlrev_b32 v232, 16, v108
    v_and_b32 v233, s46, v108
    v_lshlrev_b32 v234, 16, v109
    v_and_b32 v235, s46, v109
    v_lshlrev_b32 v236, 16, v110
    v_and_b32 v237, s46, v110
    v_lshlrev_b32 v238, 16, v111
    v_and_b32 v239, s46, v111
    v_lshlrev_b32 v240, 16, v112
    v_and_b32 v241, s46, v112
    v_lshlrev_b32 v242, 16, v113
    v_and_b32 v243, s46, v113
    v_lshlrev_b32 v244, 16, v114
    v_and_b32 v245, s46, v114
    v_lshlrev_b32 v246, 16, v115
    v_and_b32 v247, s46, v115
    v_lshlrev_b32 v248, 16, v116
    v_and_b32 v249, s46, v116
    v_lshlrev_b32 v250, 16, v117
    v_and_b32 v251, s46, v117
    v_pk_fma_f32 v[232:233], v[232:233], v[38:39], v[36:37] op_sel_hi:[1,0,0]
    v_pk_fma_f32 v[234:235], v[234:235], v[38:39], v[36:37] op_sel_hi:[1,0,0]
    v_pk_fma_f32 v[236:237], v[236:237], v[38:39], v[36:37] op_sel_hi:[1,0,0]
    v_pk_fma_f32 v[238:239], v[238:239], v[38:39], v[36:37] op_sel_hi:[1,0,0]
    v_pk_fma_f32 v[240:241], v[240:241], v[38:39], v[36:37] op_sel_hi:[1,0,0]
    v_pk_fma_f32 v[242:243], v[242:243], v[38:39], v[36:37] op_sel_hi:[1,0,0]
    v_pk_fma_f32 v[244:245], v[244:245], v[38:39], v[36:37] op_sel_hi:[1,0,0]
    v_pk_fma_f32 v[246:247], v[246:247], v[38:39], v[36:37] op_sel_hi:[1,0,0]
    v_pk_fma_f32 v[248:249], v[248:249], v[38:39], v[36:37] op_sel_hi:[1,0,0]
    v_pk_fma_f32 v[250:251], v[250:251], v[38:39], v[36:37] op_sel_hi:[1,0,0]
    v_cvt_pk_bf16_f32 v64, v232, v233
    v_cvt_pk_bf16_f32 v65, v234, v235
    v_cvt_pk_bf16_f32 v66, v236, v237
    v_cvt_pk_bf16_f32 v67, v238, v239
    v_cvt_pk_bf16_f32 v68, v240, v241
    v_cvt_pk_bf16_f32 v69, v242, v243
    v_cvt_pk_bf16_f32 v70, v244, v245
    v_cvt_pk_bf16_f32 v71, v246, v247
    v_cvt_pk_bf16_f32 v72, v248, v249
    v_cvt_pk_bf16_f32 v73, v250, v251
    s_mov_b64 s[34:35], -1
    s_mov_b64 exec, -1
    v_mov_b32 v4, 159872
    s_barrier
    ds_read_b64 v[16:17], v4
    s_cmp_eq_u32 s23, 1
    s_cbranch_scc0 C_nb4
    s_barrier
C_nb4:
    s_waitcnt lgkmcnt(0)
    v_cmp_ne_u32 vcc, v16, v15
    v_cmp_ne_u32 s[36:37], v17, v15
    s_and_b64 s[34:35], s[34:35], vcc
    s_and_b64 exec, s[34:35], s[36:37]
    s_cbranch_execz C_noc
    buffer_store_dwordx4 v[64:67], v1, s[56:59], 0 offen
    buffer_store_dwordx4 v[68:71], v1, s[56:59], 0 offen offset:16
    buffer_store_dwordx2 v[72:73], v1, s[56:59], 0 offen offset:32
C_noc:
    s_mov_b64 exec, -1
    s_branch D_ffn2
D_helper:
    s_cmp_eq_u32 s31, 0
    s_cbranch_scc1 D_poller
    s_sub_u32 s42, s32, 24
    s_cmp_ge_u32 s42, 5
    s_cbranch_scc1 L_done
    v_mov_b32 v4, 159872
    s_barrier
    s_barrier
    ds_read_b64 v[16:17], v4
    s_branch D_ffn2
D_poller:
    s_cmp_ge_u32 s32, 24
    s_cbranch_scc1 D_poll
    v_bfe_u32 v2, v0, 2, 2
    v_mul_u32_u24 v3, 20, v8
    v_add_u32 v2, v2, v3
    v_lshlrev_b32 v2, 4, v2
    v_and_b32 v3, 1, v0
    v_lshl_add_u32 v2, v3, 3, v2
    v_bfe_u32 v3, v0, 1, 1
    v_mul_u32_u24 v3, 10304, v3
    s_mov_b32 s42, 102400
    v_add3_u32 v2, v2, v3, s42
    ds_read_b64_tr_b16 v[16:17], v2 offset:0
    ds_read_b64_tr_b16 v[18:19], v2 offset:64
    ds_read_b64_tr_b16 v[20:21], v2 offset:128
    ds_read_b64_tr_b16 v[22:23], v2 offset:192
    ds_read_b64_tr_b16 v[24:25], v2 offset:1280
    ds_read_b64_tr_b16 v[26:27], v2 offset:1344
    ds_read_b64_tr_b16 v[28:29], v2 offset:1408
    ds_read_b64_tr_b16 v[30:31], v2 offset:1472
    ds_read_b64_tr_b16 v[32:33], v2 offset:2560
    ds_read_b64_tr_b16 v[34:35], v2 offset:2624
    ds_read_b64_tr_b16 v[36:37], v2 offset:2688
    ds_read_b64_tr_b16 v[38:39], v2 offset:2752
    ds_read_b64_tr_b16 v[40:41], v2 offset:3840
    ds_read_b64_tr_b16 v[42:43], v2 offset:3904
    ds_read_b64_tr_b16 v[44:45], v2 offset:3968
    ds_read_b64_tr_b16 v[46:47], v2 offset:4032
    ds_read_b64_tr_b16 v[48:49], v2 offset:5120
    ds_read_b64_tr_b16 v[50:51], v2 offset:5184
    ds_read_b64_tr_b16 v[52:53], v2 offset:5248
    ds_read_b64_tr_b16 v[54:55], v2 offset:5312
    ds_read_b64_tr_b16 v[56:57], v2 offset:6400
    ds_read_b64_tr_b16 v[58:59], v2 offset:6464
    ds_read_b64_tr_b16 v[60:61], v2 offset:6528
    ds_read_b64_tr_b16 v[62:63], v2 offset:6592
    ds_read_b64_tr_b16 v[64:65], v2 offset:7680
    ds_read_b64_tr_b16 v[66:67], v2 offset:7744
    ds_read_b64_tr_b16 v[68:69], v2 offset:7808
    ds_read_b64_tr_b16 v[70:71], v2 offset:7872
    ds_read_b64_tr_b16 v[72:73], v2 offset:8960
    ds_read_b64_tr_b16 v[74:75], v2 offset:9024
    ds_read_b64_tr_b16 v[76:77], v2 offset:9088
    ds_read_b64_tr_b16 v[78:79], v2 offset:9152
    ds_read_b64_tr_b16 v[80:81], v2 offset:256
    ds_read_b64_tr_b16 v[82:83], v2 offset:1536
    ds_read_b64_tr_b16 v[84:85], v2 offset:2816
    ds_read_b64_tr_b16 v[86:87], v2 offset:4096
    ds_read_b64_tr_b16 v[88:89], v2 offset:5376
    ds_read_b64_tr_b16 v[90:91], v2 offset:6656
    ds_read_b64_tr_b16 v[92:93], v2 offset:7936
    ds_read_b64_tr_b16 v[94:95], v2 offset:9216
    v_mov_b32 v96, 0x3f803f80
    v_mov_b32 v176, 0
    v_mov_b32 v97, 0x3f803f80
    v_mov_b32 v177, 0
    v_mov_b32 v98, 0x3f803f80
    v_mov_b32 v178, 0
    v_mov_b32 v99, 0x3f803f80
    v_mov_b32 v179, 0
    s_waitcnt lgkmcnt(0)
    s_nop 0
    v_mfma_f32_16x16x32_bf16 v[176:179], v[16:19], v[96:99], v[176:179]
    v_mfma_f32_16x16x32_bf16 v[176:179], v[20:23], v[96:99], v[176:179]
    v_mfma_f32_16x16x32_bf16 v[176:179], v[24:27], v[96:99], v[176:179]
    v_mfma_f32_16x16x32_bf16 v[176:179], v[28:31], v[96:99], v[176:179]
    v_mfma_f32_16x16x32_bf16 v[176:179], v[32:35], v[96:99], v[176:179]
    v_mfma_f32_16x16x32_bf16 v[176:179], v[36:39], v[96:99], v[176:179]
    v_mfma_f32_16x16x32_bf16 v[176:179], v[40:43], v[96:99], v[176:179]
    v_mfma_f32_16x16x32_bf16 v[176:179], v[44:47], v[96:99], v[176:179]
    v_mfma_f32_16x16x32_bf16 v[176:179], v[48:51], v[96:99], v[176:179]
    v_mfma_f32_16x16x32_bf16 v[176:179], v[52:55], v[96:99], v[176:179]
    v_mfma_f32_16x16x32_bf16 v[176:179], v[56:59], v[96:99], v[176:179]
    v_mfma_f32_16x16x32_bf16 v[176:179], v[60:63], v[96:99], v[176:179]
    v_mfma_f32_16x16x32_bf16 v[176:179], v[64:67], v[96:99], v[176:179]
    v_mfma_f32_16x16x32_bf16 v[176:179], v[68:71], v[96:99], v[176:179]
    v_mfma_f32_16x16x32_bf16 v[176:179], v[72:75], v[96:99], v[176:179]
    v_mfma_f32_16x16x32_bf16 v[176:179], v[76:79], v[96:99], v[176:179]
    v_mfma_f32_16x16x32_bf16 v[176:179], v[80:83], v[96:99], v[176:179]
    v_mfma_f32_16x16x32_bf16 v[176:179], v[84:87], v[96:99], v[176:179]
    v_mfma_f32_16x16x32_bf16 v[176:179], v[88:91], v[96:99], v[176:179]
    v_mfma_f32_16x16x32_bf16 v[176:179], v[92:95], v[96:99], v[176:179]
D_poll:
    v_lshrrev_b32 v2, 2, v0
    v_and_b32 v3, 3, v0
    v_lshl_add_u32 v2, v2, 3, v3
    v_mul_u32_u24 v2, 14336, v2
    s_mov_b32 s42, 7877632
    s_mov_b32 s43, 9712640
    s_mov_b32 s47, 262144
    s_barrier
D_p2:
    buffer_load_dwordx2 v[188:189], v2, s[16:19], s42 offen sc1
    buffer_load_dwordx2 v[190:191], v2, s[16:19], s43 offen sc1
    s_sub_u32 s47, s47, 1
    s_cbranch_scc1 D_p2d
    s_waitcnt vmcnt(0)
    v_max3_u32 v3, v188, v189, v190
    v_max_u32 v3, v3, v191
    v_cmp_eq_u32 vcc, -1, v3
    s_cbranch_vccnz D_p2
D_p2d:
    s_waitcnt vmcnt(0)
    v_max_u32 v13, v189, v191
    v_med3_u32 v13, v188, v190, v13
    v_max_u32 v12, v188, v190
    s_nop 1
    v_mov_b32_dpp v5, v12 quad_perm:[1,0,3,2] row_mask:0xf bank_mask:0xf
    v_max_u32_dpp v13, v13, v13 quad_perm:[1,0,3,2] row_mask:0xf bank_mask:0xf
    v_med3_u32 v13, v12, v5, v13
    v_max_u32 v12, v12, v5
    s_nop 1
    v_mov_b32_dpp v5, v12 quad_perm:[2,3,0,1] row_mask:0xf bank_mask:0xf
    v_max_u32_dpp v13, v13, v13 quad_perm:[2,3,0,1] row_mask:0xf bank_mask:0xf
    v_med3_u32 v13, v12, v5, v13
    v_max_u32 v12, v12, v5
    s_nop 1
    v_mov_b32_dpp v5, v12 row_half_mirror row_mask:0xf bank_mask:0xf
    v_max_u32_dpp v13, v13, v13 row_half_mirror row_mask:0xf bank_mask:0xf
    v_med3_u32 v13, v12, v5, v13
    v_max_u32 v12, v12, v5
    s_nop 1
    v_mov_b32_dpp v5, v12 row_mirror row_mask:0xf bank_mask:0xf
    v_max_u32_dpp v13, v13, v13 row_mirror row_mask:0xf bank_mask:0xf
    v_med3_u32 v13, v12, v5, v13
    v_max_u32 v12, v12, v5
    v_mov_b32 v5, v12
    v_mov_b32 v6, v13
    s_nop 0
    v_permlane16_swap_b32 v5, v12
    v_permlane16_swap_b32 v6, v13
    v_max_u32 v13, v13, v6
    v_med3_u32 v13, v12, v5, v13
    v_max_u32 v12, v12, v5
    v_mov_b32 v5, v12
    v_mov_b32 v6, v13
    s_nop 0
    v_permlane32_swap_b32 v5, v12
    v_permlane32_swap_b32 v6, v13
    v_max_u32 v13, v13, v6
    v_med3_u32 v13, v12, v5, v13
    v_max_u32 v12, v12, v5
    v_and_b32 v12, 0x7ff, v12
    v_and_b32 v13, 0x7ff, v13
    v_sub_u32 v12, 2047, v12
    v_sub_u32 v13, 2047, v13
    v_mov_b32 v4, 159872
    ds_write_b64 v4, v[12:13]
    s_cmp_lt_u32 s32, 24
    s_cbranch_scc1 D_ffn1
    v_mov_b32 v16, v12
    v_mov_b32 v17, v13
    s_waitcnt lgkmcnt(0)
    s_barrier
    s_branch D_ffn2
D_ffn1:
    v_xor_b32 v5, v12, v13
    v_and_b32 v6, 1, v0
    v_cmp_gt_u32 vcc, 16, v5
    v_cmp_eq_u32 s[36:37], 1, v6
    s_and_b64 vcc, vcc, s[36:37]
    s_nop 0
    v_cndmask_b32 v6, v12, v13, s[36:37]
    v_cndmask_b32 v5, 0, 1, vcc
    v_lshrrev_b32 v2, 6, v6
    v_mul_u32_u24 v2, 114688, v2
    v_lshl_add_u32 v2, v5, 8, v2
    v_bfe_u32 v5, v6, 4, 2
    v_lshl_add_u32 v2, v5, 9, v2
    v_lshl_add_u32 v3, v8, 3, v2
    v_lshl_add_u32 v4, v8, 4, v2
    s_mov_b32 s36, 0x00030003
    s_mov_b32 s37, 0x00030003
    s_mov_b32 s47, 262144
    s_mov_b32 s46, 0
D_p3:
    s_mov_b64 exec, s[36:37]
    s_mov_b32 s42, 7875584
    buffer_load_dwordx4 v[96:99], v4, s[16:19], s42 offen sc1
    buffer_load_dwordx4 v[100:103], v4, s[16:19], s42 offen offset:64 sc1
    buffer_load_dwordx2 v[160:161], v3, s[16:19], s42 offen offset:128 sc1
    s_mov_b32 s42, 7889920
    buffer_load_dwordx4 v[104:107], v4, s[16:19], s42 offen sc1
    buffer_load_dwordx4 v[108:111], v4, s[16:19], s42 offen offset:64 sc1
    buffer_load_dwordx2 v[162:163], v3, s[16:19], s42 offen offset:128 sc1
    s_mov_b32 s42, 7904256
    buffer_load_dwordx4 v[112:115], v4, s[16:19], s42 offen sc1
    buffer_load_dwordx4 v[116:119], v4, s[16:19], s42 offen offset:64 sc1
    buffer_load_dwordx2 v[164:165], v3, s[16:19], s42 offen offset:128 sc1
    s_mov_b32 s42, 7918592
    buffer_load_dwordx4 v[120:123], v4, s[16:19], s42 offen sc1
    buffer_load_dwordx4 v[124:127], v4, s[16:19], s42 offen offset:64 sc1
    buffer_load_dwordx2 v[166:167], v3, s[16:19], s42 offen offset:128 sc1
    s_mov_b32 s42, 7932928
    buffer_load_dwordx4 v[128:131], v4, s[16:19], s42 offen sc1
    buffer_load_dwordx4 v[132:135], v4, s[16:19], s42 offen offset:64 sc1
    buffer_load_dwordx2 v[168:169], v3, s[16:19], s42 offen offset:128 sc1
    s_mov_b32 s42, 7947264
    buffer_load_dwordx4 v[136:139], v4, s[16:19], s42 offen sc1
    buffer_load_dwordx4 v[140:143], v4, s[16:19], s42 offen offset:64 sc1
    buffer_load_dwordx2 v[170:171], v3, s[16:19], s42 offen offset:128 sc1
    s_mov_b32 s42, 7961600
    buffer_load_dwordx4 v[144:147], v4, s[16:19], s42 offen sc1
    buffer_load_dwordx4 v[148:151], v4, s[16:19], s42 offen offset:64 sc1
    buffer_load_dwordx2 v[172:173], v3, s[16:19], s42 offen offset:128 sc1
    s_mov_b32 s42, 7975936
    buffer_load_dwordx4 v[152:155], v4, s[16:19], s42 offen sc1
    buffer_load_dwordx4 v[156:159], v4, s[16:19], s42 offen offset:64 sc1
    buffer_load_dwordx2 v[174:175], v3, s[16:19], s42 offen offset:128 sc1
    buffer_load_dwordx4 v[184:187], v2, s[16:19], s42 offen offset:160 sc1
    s_mov_b64 exec, -1
    v_mov_b32 v5, 0
    s_cmp_lg_u32 s46, 0
    s_cbranch_scc1 D_p3b
    s_mov_b32 s46, 1
    s_waitcnt lgkmcnt(0)
    s_barrier
D_p3b:
    s_waitcnt vmcnt(24)
    v_mfma_f32_16x16x32_bf16 v[180:183], v[16:19], v[96:99], 0
    v_max3_u32 v5, v5, v96, v97
    v_max3_u32 v5, v5, v98, v99
    s_waitcnt vmcnt(23)
    v_mfma_f32_16x16x32_bf16 v[180:183], v[20:23], v[100:103], v[180:183]
    v_max3_u32 v5, v5, v100, v101
    v_max3_u32 v5, v5, v102, v103
    s_waitcnt vmcnt(21)
    v_mfma_f32_16x16x32_bf16 v[180:183], v[24:27], v[104:107], v[180:183]
    v_max3_u32 v5, v5, v104, v105
    v_max3_u32 v5, v5, v106, v107
    s_waitcnt vmcnt(20)
    v_mfma_f32_16x16x32_bf16 v[180:183], v[28:31], v[108:111], v[180:183]
    v_max3_u32 v5, v5, v108, v109
    v_max3_u32 v5, v5, v110, v111
    s_waitcnt vmcnt(19)
    v_mfma_f32_16x16x32_bf16 v[180:183], v[80:83], v[160:163], v[180:183]
    v_max3_u32 v5, v5, v160, v161
    v_max3_u32 v5, v5, v162, v163
    s_waitcnt vmcnt(18)
    v_mfma_f32_16x16x32_bf16 v[180:183], v[32:35], v[112:115], v[180:183]
    v_max3_u32 v5, v5, v112, v113
    v_max3_u32 v5, v5, v114, v115
    s_waitcnt vmcnt(17)
    v_mfma_f32_16x16x32_bf16 v[180:183], v[36:39], v[116:119], v[180:183]
    v_max3_u32 v5, v5, v116, v117
    v_max3_u32 v5, v5, v118, v119
    s_waitcnt vmcnt(15)
    v_mfma_f32_16x16x32_bf16 v[180:183], v[40:43], v[120:123], v[180:183]
    v_max3_u32 v5, v5, v120, v121
    v_max3_u32 v5, v5, v122, v123
    s_waitcnt vmcnt(14)
    v_mfma_f32_16x16x32_bf16 v[180:183], v[44:47], v[124:127], v[180:183]
    v_max3_u32 v5, v5, v124, v125
    v_max3_u32 v5, v5, v126, v127
    s_waitcnt vmcnt(13)
    v_mfma_f32_16x16x32_bf16 v[180:183], v[84:87], v[164:167], v[180:183]
    v_max3_u32 v5, v5, v164, v165
    v_max3_u32 v5, v5, v166, v167
    s_waitcnt vmcnt(12)
    v_mfma_f32_16x16x32_bf16 v[180:183], v[48:51], v[128:131], v[180:183]
    v_max3_u32 v5, v5, v128, v129
    v_max3_u32 v5, v5, v130, v131
    s_waitcnt vmcnt(11)
    v_mfma_f32_16x16x32_bf16 v[180:183], v[52:55], v[132:135], v[180:183]
    v_max3_u32 v5, v5, v132, v133
    v_max3_u32 v5, v5, v134, v135
    s_waitcnt vmcnt(9)
    v_mfma_f32_16x16x32_bf16 v[180:183], v[56:59], v[136:139], v[180:183]
    v_max3_u32 v5, v5, v136, v137
    v_max3_u32 v5, v5, v138, v139
    s_waitcnt vmcnt(8)
    v_mfma_f32_16x16x32_bf16 v[180:183], v[60:63], v[140:143], v[180:183]
    v_max3_u32 v5, v5, v140, v141
    v_max3_u32 v5, v5, v142, v143
    s_waitcnt vmcnt(7)
    v_mfma_f32_16x16x32_bf16 v[180:183], v[88:91], v[168:171], v[180:183]
    v_max3_u32 v5, v5, v168, v169
    v_max3_u32 v5, v5, v170, v171
    s_waitcnt vmcnt(6)
    v_mfma_f32_16x16x32_bf16 v[180:183], v[64:67], v[144:147], v[180:183]
    v_max3_u32 v5, v5, v144, v145
    v_max3_u32 v5, v5, v146, v147
    s_waitcnt vmcnt(5)
    v_mfma_f32_16x16x32_bf16 v[180:183], v[68:71], v[148:151], v[180:183]
    v_max3_u32 v5, v5, v148, v149
    v_max3_u32 v5, v5, v150, v151
    s_waitcnt vmcnt(3)
    v_mfma_f32_16x16x32_bf16 v[180:183], v[72:75], v[152:155], v[180:183]
    v_max3_u32 v5, v5, v152, v153
    v_max3_u32 v5, v5, v154, v155
    s_waitcnt vmcnt(2)
    v_mfma_f32_16x16x32_bf16 v[180:183], v[76:79], v[156:159], v[180:183]
    v_max3_u32 v5, v5, v156, v157
    v_max3_u32 v5, v5, v158, v159
    s_waitcnt vmcnt(1)
    v_mfma_f32_16x16x32_bf16 v[180:183], v[92:95], v[172:175], v[180:183]
    v_max3_u32 v5, v5, v172, v173
    v_max3_u32 v5, v5, v174, v175
    s_waitcnt vmcnt(0)
    v_max3_u32 v5, v5, v184, v185
    s_sub_u32 s47, s47, 1
    s_cbranch_scc1 D_p3d
    v_cmp_eq_u32 vcc, -1, v5
    s_and_b64 vcc, vcc, s[36:37]
    s_cbranch_scc1 D_p3
D_p3d:
    v_lshlrev_b32 v2, 4, v7
    v_lshl_add_u32 v2, v8, 3, v2
    s_add_u32 s42, s39, 13440
    v_fma_f32 v180, -v184, v176, v180
    v_fma_f32 v181, -v184, v177, v181
    v_fma_f32 v182, -v184, v178, v182
    v_fma_f32 v183, -v184, v179, v183
    v_mul_f32 v180, v180, v185
    v_mul_f32 v181, v181, v185
    v_mul_f32 v182, v182, v185
    v_mul_f32 v183, v183, v185
    v_mov_b32 v176, v180
    v_mov_b32 v177, v181
    v_mov_b32 v178, v182
    v_mov_b32 v179, v183
    v_permlane32_swap_b32 v176, v180
    v_permlane32_swap_b32 v177, v181
    v_permlane32_swap_b32 v178, v182
    v_permlane32_swap_b32 v179, v183
    v_mul_f32 v188, 0xbfb8aa3b, v176
    v_mul_f32 v189, 0xbfb8aa3b, v177
    v_mul_f32 v190, 0xbfb8aa3b, v178
    v_mul_f32 v191, 0xbfb8aa3b, v179
    v_exp_f32 v188, v188
    v_exp_f32 v189, v189
    v_exp_f32 v190, v190
    v_exp_f32 v191, v191
    v_mul_f32 v180, v180, v176
    v_mul_f32 v181, v181, v177
    v_mul_f32 v182, v182, v178
    v_mul_f32 v183, v183, v179
    v_add_f32 v188, 1.0, v188
    v_add_f32 v189, 1.0, v189
    v_add_f32 v190, 1.0, v190
    v_add_f32 v191, 1.0, v191
    v_rcp_f32 v188, v188
    v_rcp_f32 v189, v189
    v_rcp_f32 v190, v190
    v_rcp_f32 v191, v191
    v_mul_f32 v180, v180, v188
    v_mul_f32 v181, v181, v189
    v_mul_f32 v182, v182, v190
    v_mul_f32 v183, v183, v191
    v_cvt_pk_bf16_f32 v180, v180, v181
    v_cvt_pk_bf16_f32 v181, v182, v183
    v_min_u32 v180, -2, v180
    v_min_u32 v181, -2, v181
    s_mov_b64 exec, 0x00030003
    buffer_store_dwordx2 v[180:181], v2, s[16:19], s42 offen sc1
    s_branch L_done
D_ffn2:
    s_sub_u32 s42, s32, 24
    s_cmp_ge_u32 s42, 5
    s_cbranch_scc1 L_done
    s_mul_i32 s43, s33, 5
    s_add_u32 s41, s42, s43
    s_waitcnt lgkmcnt(0)
    v_xor_b32 v5, v16, v17
    v_and_b32 v13, 1, v0
    v_cmp_gt_u32 vcc, 16, v5
    v_cmp_eq_u32 s[36:37], 1, v13
    s_and_b64 vcc, vcc, s[36:37]
    s_nop 0
    v_cndmask_b32 v13, v16, v17, s[36:37]
    v_cndmask_b32 v5, 0, 1, vcc
    v_lshrrev_b32 v12, 6, v13
    v_mul_u32_u24 v12, 114688, v12
    v_lshl_add_u32 v12, v5, 8, v12
    v_bfe_u32 v5, v13, 4, 2
    v_lshl_add_u32 v12, v5, 9, v12
    s_lshl_b32 s42, s41, 2
    v_add_u32 v2, s42, v8
    v_mul_u32_u24 v3, 205, v2
    v_lshrrev_b32 v3, 10, v3
    v_mul_u32_u24 v4, 5, v3
    v_sub_u32 v4, v2, v4
    v_lshrrev_b32 v5, 2, v3
    v_mul_u32_u24 v5, 14336, v5
    v_add_u32 v12, v12, v5
    v_and_b32 v3, 3, v3
    v_lshrrev_b32 v5, 1, v4
    v_lshlrev_b32 v5, 6, v5
    v_and_b32 v6, 1, v4
    v_lshl_add_u32 v5, v6, 3, v5
    v_cmp_eq_u32 vcc, 4, v4
    v_lshlrev_b32 v6, 4, v3
    v_lshlrev_b32 v3, 3, v3
    v_cndmask_b32 v3, v6, v3, vcc
    v_add3_u32 v14, v12, v5, v3
    v_mul_u32_u24 v13, 1280, v13
    v_lshl_add_u32 v13, v2, 3, v13
    v_mul_u32_u24 v2, 114688, v8
    v_lshl_add_u32 v2, v7, 4, v2
    s_mul_i32 s42, s20, 458752
    s_add_u32 s42, s42, 7877760
    s_mov_b32 s40, 7875584
    s_mov_b32 s36, 0x00030003
    s_mov_b32 s37, 0x00030003
    s_mov_b32 s47, 262144
    s_mov_b64 exec, s[36:37]
D_p5:
    buffer_load_dwordx2 v[76:77], v14, s[16:19], s40 offen sc1
    buffer_load_dwordx4 v[80:83], v12, s[16:19], s40 offen offset:160 sc1
    s_sub_u32 s47, s47, 1
    s_cbranch_scc1 D_p5d
    s_waitcnt vmcnt(0)
    v_max3_u32 v5, v76, v77, v80
    v_max3_u32 v5, v5, v81, v82
    v_cmp_eq_u32 vcc, -1, v5
    s_cbranch_vccnz D_p5
D_p5d:
    s_waitcnt vmcnt(0)
    s_mov_b32 s46, 0xffff0000
    v_mul_f32 v80, -v80, v81
    v_add_f32 v81, 1.0, v81
    v_lshlrev_b32 v84, 16, v76
    v_and_b32 v85, s46, v76
    v_lshlrev_b32 v86, 16, v77
    v_and_b32 v87, s46, v77
    v_fma_f32 v84, v84, v81, v80
    v_fma_f32 v85, v85, v81, v80
    v_fma_f32 v86, v86, v81, v80
    v_fma_f32 v87, v87, v81, v80
    s_mov_b32 s47, 262144
D_p4:
    s_add_u32 s43, s42, 0
    buffer_load_dwordx4 v[88:91], v2, s[16:19], s43 offen sc1
    s_add_u32 s43, s42, 14336
    buffer_load_dwordx4 v[92:95], v2, s[16:19], s43 offen sc1
    s_add_u32 s43, s42, 28672
    buffer_load_dwordx4 v[96:99], v2, s[16:19], s43 offen sc1
    s_add_u32 s43, s42, 43008
    buffer_load_dwordx4 v[100:103], v2, s[16:19], s43 offen sc1
    s_add_u32 s43, s42, 57344
    buffer_load_dwordx4 v[104:107], v2, s[16:19], s43 offen sc1
    s_add_u32 s43, s42, 71680
    buffer_load_dwordx4 v[108:111], v2, s[16:19], s43 offen sc1
    s_sub_u32 s47, s47, 1
    s_cbranch_scc1 D_p4d
    s_waitcnt vmcnt(0)
    v_max_u32 v5, v88, v89
    v_max3_u32 v5, v5, v90, v91
    v_max3_u32 v5, v5, v92, v93
    v_max3_u32 v5, v5, v94, v95
    v_max3_u32 v5, v5, v96, v97
    v_max3_u32 v5, v5, v98, v99
    v_max3_u32 v5, v5, v100, v101
    v_max3_u32 v5, v5, v102, v103
    v_max3_u32 v5, v5, v104, v105
    v_max3_u32 v5, v5, v106, v107
    v_max3_u32 v5, v5, v108, v109
    v_max3_u32 v5, v5, v110, v111
    v_cmp_eq_u32 vcc, -1, v5
    s_cbranch_vccnz D_p4
D_p4d:
    s_waitcnt vmcnt(0)
    s_mov_b64 exec, -1
    v_mfma_f32_16x16x32_bf16 v[112:115], v[128:131], v[88:91], 0
    v_mfma_f32_16x16x32_bf16 v[112:115], v[132:135], v[92:95], v[112:115]
    v_mfma_f32_16x16x32_bf16 v[112:115], v[136:139], v[96:99], v[112:115]
    v_mfma_f32_16x16x32_bf16 v[112:115], v[140:143], v[100:103], v[112:115]
    v_mfma_f32_16x16x32_bf16 v[112:115], v[144:147], v[104:107], v[112:115]
    v_mfma_f32_16x16x32_bf16 v[112:115], v[148:151], v[108:111], v[112:115]
    s_lshl_b32 s42, s20, 10
    v_add_u32 v4, s42, v9
    s_nop 5
    ds_write_b128 v4, v[112:115]
    s_waitcnt lgkmcnt(0)
    s_barrier
    s_cmp_lg_u32 s20, 0
    s_cbranch_scc1 L_done
    ds_read_b128 v[24:27], v4 offset:1024
    ds_read_b128 v[28:31], v4 offset:2048
    ds_read_b128 v[32:35], v4 offset:3072
    ds_read_b128 v[36:39], v4 offset:4096
    ds_read_b128 v[40:43], v4 offset:5120
    ds_read_b128 v[44:47], v4 offset:6144
    ds_read_b128 v[48:51], v4 offset:7168
    s_waitcnt lgkmcnt(6)
    v_pk_add_f32 v[112:113], v[112:113], v[24:25]
    v_pk_add_f32 v[114:115], v[114:115], v[26:27]
    s_waitcnt lgkmcnt(5)
    v_pk_add_f32 v[112:113], v[112:113], v[28:29]
    v_pk_add_f32 v[114:115], v[114:115], v[30:31]
    s_waitcnt lgkmcnt(4)
    v_pk_add_f32 v[112:113], v[112:113], v[32:33]
    v_pk_add_f32 v[114:115], v[114:115], v[34:35]
    s_waitcnt lgkmcnt(3)
    v_pk_add_f32 v[112:113], v[112:113], v[36:37]
    v_pk_add_f32 v[114:115], v[114:115], v[38:39]
    s_waitcnt lgkmcnt(2)
    v_pk_add_f32 v[112:113], v[112:113], v[40:41]
    v_pk_add_f32 v[114:115], v[114:115], v[42:43]
    s_waitcnt lgkmcnt(1)
    v_pk_add_f32 v[112:113], v[112:113], v[44:45]
    v_pk_add_f32 v[114:115], v[114:115], v[46:47]
    s_waitcnt lgkmcnt(0)
    v_pk_add_f32 v[112:113], v[112:113], v[48:49]
    v_pk_add_f32 v[114:115], v[114:115], v[50:51]
    v_fma_f32 v84, v112, v82, v84
    v_fma_f32 v85, v113, v82, v85
    v_fma_f32 v86, v114, v82, v86
    v_fma_f32 v87, v115, v82, v87
    v_cvt_pk_bf16_f32 v84, v84, v85
    v_cvt_pk_bf16_f32 v85, v86, v87
    s_mov_b64 exec, s[36:37]
    buffer_store_dwordx2 v[84:85], v13, s[56:59], 0 offen
L_done:
L_exit:
    s_endpgm
C_round:
    s_and_b32 s43, s46, 1
    s_cmp_eq_u32 s43, 1
    s_cbranch_scc0 C_SK0
    s_waitcnt vmcnt(11)
    v_min3_i32 v4, v200, v201, v202
    v_min_i32 v4, v4, v203
    v_cmp_gt_i32 vcc, s41, v4
    s_cbranch_vccnz C_SK0
    s_bitset0_b32 s46, 0
    v_mfma_f32_16x16x32_bf16 v[232:235], v[56:59], v[200:203], v[232:235]
    ds_read_b64_tr_b16 v[56:57], v12 offset:0
    ds_read_b64_tr_b16 v[58:59], v12 offset:1280
    v_mfma_f32_16x16x32_bf16 v[236:239], v[60:63], v[200:203], v[236:239]
    ds_read_b64_tr_b16 v[60:61], v12 offset:8
    ds_read_b64_tr_b16 v[62:63], v12 offset:1288
    v_mfma_f32_16x16x32_bf16 v[240:243], v[64:67], v[200:203], v[240:243]
    ds_read_b64_tr_b16 v[64:65], v12 offset:16
    ds_read_b64_tr_b16 v[66:67], v12 offset:1296
    v_mfma_f32_16x16x32_bf16 v[244:247], v[68:71], v[200:203], v[244:247]
    ds_read_b64_tr_b16 v[68:69], v12 offset:24
    ds_read_b64_tr_b16 v[70:71], v12 offset:1304
    v_mfma_f32_16x16x32_bf16 v[248:251], v[72:75], v[200:203], v[248:251]
    ds_read_b64_tr_b16 v[72:73], v12 offset:32
    ds_read_b64_tr_b16 v[74:75], v12 offset:1312
C_SK0:
    s_and_b32 s43, s46, 2
    s_cmp_eq_u32 s43, 2
    s_cbranch_scc0 C_SK1
    s_waitcnt vmcnt(10)
    v_min3_i32 v4, v204, v205, v206
    v_min_i32 v4, v4, v207
    v_cmp_gt_i32 vcc, s41, v4
    s_cbranch_vccnz C_SK1
    s_bitset0_b32 s46, 1
    v_mfma_f32_16x16x32_bf16 v[232:235], v[76:79], v[204:207], v[232:235]
    ds_read_b64_tr_b16 v[76:77], v12 offset:6400
    ds_read_b64_tr_b16 v[78:79], v12 offset:7680
    v_mfma_f32_16x16x32_bf16 v[236:239], v[80:83], v[204:207], v[236:239]
    ds_read_b64_tr_b16 v[80:81], v12 offset:6408
    ds_read_b64_tr_b16 v[82:83], v12 offset:7688
    v_mfma_f32_16x16x32_bf16 v[240:243], v[84:87], v[204:207], v[240:243]
    ds_read_b64_tr_b16 v[84:85], v12 offset:6416
    ds_read_b64_tr_b16 v[86:87], v12 offset:7696
    v_mfma_f32_16x16x32_bf16 v[244:247], v[88:91], v[204:207], v[244:247]
    ds_read_b64_tr_b16 v[88:89], v12 offset:6424
    ds_read_b64_tr_b16 v[90:91], v12 offset:7704
    v_mfma_f32_16x16x32_bf16 v[248:251], v[92:95], v[204:207], v[248:251]
    ds_read_b64_tr_b16 v[92:93], v12 offset:6432
    ds_read_b64_tr_b16 v[94:95], v12 offset:7712
C_SK1:
    s_and_b32 s43, s46, 4
    s_cmp_eq_u32 s43, 4
    s_cbranch_scc0 C_SK2
    s_waitcnt vmcnt(9)
    v_min3_i32 v4, v208, v209, v210
    v_min_i32 v4, v4, v211
    v_cmp_gt_i32 vcc, s41, v4
    s_cbranch_vccnz C_SK2
    s_bitset0_b32 s46, 2
    v_mfma_f32_16x16x32_bf16 v[232:235], v[160:163], v[208:211], v[232:235]
    ds_read_b64_tr_b16 v[160:161], v12 offset:12800
    ds_read_b64_tr_b16 v[162:163], v12 offset:14080
    v_mfma_f32_16x16x32_bf16 v[236:239], v[164:167], v[208:211], v[236:239]
    ds_read_b64_tr_b16 v[164:165], v12 offset:12808
    ds_read_b64_tr_b16 v[166:167], v12 offset:14088
    v_mfma_f32_16x16x32_bf16 v[240:243], v[168:171], v[208:211], v[240:243]
    ds_read_b64_tr_b16 v[168:169], v12 offset:12816
    ds_read_b64_tr_b16 v[170:171], v12 offset:14096
    v_mfma_f32_16x16x32_bf16 v[244:247], v[172:175], v[208:211], v[244:247]
    ds_read_b64_tr_b16 v[172:173], v12 offset:12824
    ds_read_b64_tr_b16 v[174:175], v12 offset:14104
    v_mfma_f32_16x16x32_bf16 v[248:251], v[176:179], v[208:211], v[248:251]
    ds_read_b64_tr_b16 v[176:177], v12 offset:12832
    ds_read_b64_tr_b16 v[178:179], v12 offset:14112
C_SK2:
    s_and_b32 s43, s46, 8
    s_cmp_eq_u32 s43, 8
    s_cbranch_scc0 C_SK3
    s_waitcnt vmcnt(8)
    v_min3_i32 v4, v212, v213, v214
    v_min_i32 v4, v4, v215
    v_cmp_gt_i32 vcc, s41, v4
    s_cbranch_vccnz C_SK3
    s_bitset0_b32 s46, 3
    v_mfma_f32_16x16x32_bf16 v[232:235], v[180:183], v[212:215], v[232:235]
    ds_read_b64_tr_b16 v[180:181], v12 offset:19200
    ds_read_b64_tr_b16 v[182:183], v12 offset:20480
    v_mfma_f32_16x16x32_bf16 v[236:239], v[184:187], v[212:215], v[236:239]
    ds_read_b64_tr_b16 v[184:185], v12 offset:19208
    ds_read_b64_tr_b16 v[186:187], v12 offset:20488
    v_mfma_f32_16x16x32_bf16 v[240:243], v[188:191], v[212:215], v[240:243]
    ds_read_b64_tr_b16 v[188:189], v12 offset:19216
    ds_read_b64_tr_b16 v[190:191], v12 offset:20496
    v_mfma_f32_16x16x32_bf16 v[244:247], v[192:195], v[212:215], v[244:247]
    ds_read_b64_tr_b16 v[192:193], v12 offset:19224
    ds_read_b64_tr_b16 v[194:195], v12 offset:20504
    v_mfma_f32_16x16x32_bf16 v[248:251], v[196:199], v[212:215], v[248:251]
    ds_read_b64_tr_b16 v[196:197], v12 offset:19232
    ds_read_b64_tr_b16 v[198:199], v12 offset:20512
C_SK3:
    s_and_b32 s43, s46, 256
    s_cmp_eq_u32 s43, 256
    s_cbranch_scc0 C_SK8
    s_waitcnt vmcnt(6)
    v_min3_i32 v4, v152, v153, v154
    v_min_i32 v4, v4, v155
    v_cmp_gt_i32 vcc, s41, v4
    s_cbranch_vccnz C_SK8
    s_bitset0_b32 s46, 8
    v_mfma_f32_16x16x32_bf16 v[232:235], v[16:19], v[152:155], v[232:235]
    v_mfma_f32_16x16x32_bf16 v[236:239], v[20:23], v[152:155], v[236:239]
    v_mfma_f32_16x16x32_bf16 v[240:243], v[24:27], v[152:155], v[240:243]
    v_mfma_f32_16x16x32_bf16 v[244:247], v[28:31], v[152:155], v[244:247]
    v_mfma_f32_16x16x32_bf16 v[248:251], v[32:35], v[152:155], v[248:251]
C_SK8:
    s_and_b32 s43, s46, 512
    s_cmp_eq_u32 s43, 512
    s_cbranch_scc0 C_SK9
    s_waitcnt vmcnt(4)
    v_min3_i32 v4, v156, v157, v158
    v_min_i32 v4, v4, v159
    v_cmp_gt_i32 vcc, s41, v4
    s_cbranch_vccnz C_SK9
    s_bitset0_b32 s46, 9
    v_mfma_f32_16x16x32_bf16 v[232:235], v[36:39], v[156:159], v[232:235]
    v_mfma_f32_16x16x32_bf16 v[236:239], v[40:43], v[156:159], v[236:239]
    v_mfma_f32_16x16x32_bf16 v[240:243], v[44:47], v[156:159], v[240:243]
    v_mfma_f32_16x16x32_bf16 v[244:247], v[48:51], v[156:159], v[244:247]
    v_mfma_f32_16x16x32_bf16 v[248:251], v[52:55], v[156:159], v[248:251]
C_SK9:
    s_and_b32 s43, s46, 17
    s_cmp_eq_u32 s43, 16
    s_cbranch_scc0 C_SK4
    s_waitcnt vmcnt(3)
    v_min3_i32 v4, v216, v217, v218
    v_min_i32 v4, v4, v219
    v_cmp_gt_i32 vcc, s41, v4
    s_cbranch_vccnz C_SK4
    s_bitset0_b32 s46, 4
    s_waitcnt lgkmcnt(0)
    v_mfma_f32_16x16x32_bf16 v[232:235], v[56:59], v[216:219], v[232:235]
    v_mfma_f32_16x16x32_bf16 v[236:239], v[60:63], v[216:219], v[236:239]
    v_mfma_f32_16x16x32_bf16 v[240:243], v[64:67], v[216:219], v[240:243]
    v_mfma_f32_16x16x32_bf16 v[244:247], v[68:71], v[216:219], v[244:247]
    v_mfma_f32_16x16x32_bf16 v[248:251], v[72:75], v[216:219], v[248:251]
C_SK4:
    s_and_b32 s43, s46, 34
    s_cmp_eq_u32 s43, 32
    s_cbranch_scc0 C_SK5
    s_waitcnt vmcnt(2)
    v_min3_i32 v4, v220, v221, v222
    v_min_i32 v4, v4, v223
    v_cmp_gt_i32 vcc, s41, v4
    s_cbranch_vccnz C_SK5
    s_bitset0_b32 s46, 5
    s_waitcnt lgkmcnt(0)
    v_mfma_f32_16x16x32_bf16 v[232:235], v[76:79], v[220:223], v[232:235]
    v_mfma_f32_16x16x32_bf16 v[236:239], v[80:83], v[220:223], v[236:239]
    v_mfma_f32_16x16x32_bf16 v[240:243], v[84:87], v[220:223], v[240:243]
    v_mfma_f32_16x16x32_bf16 v[244:247], v[88:91], v[220:223], v[244:247]
    v_mfma_f32_16x16x32_bf16 v[248:251], v[92:95], v[220:223], v[248:251]
C_SK5:
    s_and_b32 s43, s46, 68
    s_cmp_eq_u32 s43, 64
    s_cbranch_scc0 C_SK6
    s_waitcnt vmcnt(1)
    v_min3_i32 v4, v224, v225, v226
    v_min_i32 v4, v4, v227
    v_cmp_gt_i32 vcc, s41, v4
    s_cbranch_vccnz C_SK6
    s_bitset0_b32 s46, 6
    s_waitcnt lgkmcnt(0)
    v_mfma_f32_16x16x32_bf16 v[232:235], v[160:163], v[224:227], v[232:235]
    v_mfma_f32_16x16x32_bf16 v[236:239], v[164:167], v[224:227], v[236:239]
    v_mfma_f32_16x16x32_bf16 v[240:243], v[168:171], v[224:227], v[240:243]
    v_mfma_f32_16x16x32_bf16 v[244:247], v[172:175], v[224:227], v[244:247]
    v_mfma_f32_16x16x32_bf16 v[248:251], v[176:179], v[224:227], v[248:251]
C_SK6:
    s_and_b32 s43, s46, 136
    s_cmp_eq_u32 s43, 128
    s_cbranch_scc0 C_SK7
    s_waitcnt vmcnt(0)
    v_min3_i32 v4, v228, v229, v230
    v_min_i32 v4, v4, v231
    v_cmp_gt_i32 vcc, s41, v4
    s_cbranch_vccnz C_SK7
    s_bitset0_b32 s46, 7
    s_waitcnt lgkmcnt(0)
    v_mfma_f32_16x16x32_bf16 v[232:235], v[180:183], v[228:231], v[232:235]
    v_mfma_f32_16x16x32_bf16 v[236:239], v[184:187], v[228:231], v[236:239]
    v_mfma_f32_16x16x32_bf16 v[240:243], v[188:191], v[228:231], v[240:243]
    v_mfma_f32_16x16x32_bf16 v[244:247], v[192:195], v[228:231], v[244:247]
    v_mfma_f32_16x16x32_bf16 v[248:251], v[196:199], v[228:231], v[248:251]
C_SK7:
    s_cmp_eq_u32 s46, 0
    s_cbranch_scc1 C_full
    s_bitcmp1_b32 s46, 0
    s_cbranch_scc0 C_NL0
    s_mov_b32 s43, 7864320
    buffer_load_dwordx4 v[200:203], v254, s[16:19], s43 offen sc1
C_NL0:
    s_bitcmp1_b32 s46, 1
    s_cbranch_scc0 C_NL1
    s_mov_b32 s43, 8093696
    buffer_load_dwordx4 v[204:207], v254, s[16:19], s43 offen sc1
C_NL1:
    s_bitcmp1_b32 s46, 2
    s_cbranch_scc0 C_NL2
    s_mov_b32 s43, 8323072
    buffer_load_dwordx4 v[208:211], v254, s[16:19], s43 offen sc1
C_NL2:
    s_bitcmp1_b32 s46, 3
    s_cbranch_scc0 C_NL3
    s_mov_b32 s43, 8552448
    buffer_load_dwordx4 v[212:215], v254, s[16:19], s43 offen sc1
C_NL3:
    s_bitcmp1_b32 s46, 8
    s_cbranch_scc0 C_NL8
    s_mov_b32 s43, 7864320
    buffer_load_dwordx2 v[152:153], v255, s[16:19], s43 offen offset:1024 sc1
    s_mov_b32 s43, 7979008
    buffer_load_dwordx2 v[154:155], v255, s[16:19], s43 offen offset:1024 sc1
C_NL8:
    s_bitcmp1_b32 s46, 9
    s_cbranch_scc0 C_NL9
    s_mov_b32 s43, 8781824
    buffer_load_dwordx2 v[156:157], v255, s[16:19], s43 offen offset:1024 sc1
    s_mov_b32 s43, 8896512
    buffer_load_dwordx2 v[158:159], v255, s[16:19], s43 offen offset:1024 sc1
C_NL9:
    s_bitcmp1_b32 s46, 4
    s_cbranch_scc0 C_NL4
    s_mov_b32 s43, 7864320
    buffer_load_dwordx4 v[216:219], v13, s[16:19], s43 offen sc1
C_NL4:
    s_bitcmp1_b32 s46, 5
    s_cbranch_scc0 C_NL5
    s_mov_b32 s43, 8093696
    buffer_load_dwordx4 v[220:223], v13, s[16:19], s43 offen sc1
C_NL5:
    s_bitcmp1_b32 s46, 6
    s_cbranch_scc0 C_NL6
    s_mov_b32 s43, 8323072
    buffer_load_dwordx4 v[224:227], v13, s[16:19], s43 offen sc1
C_NL6:
    s_bitcmp1_b32 s46, 7
    s_cbranch_scc0 C_NL7
    s_mov_b32 s43, 8552448
    buffer_load_dwordx4 v[228:231], v13, s[16:19], s43 offen sc1
C_NL7:
    s_sub_u32 s47, s47, 1
    s_cselect_b32 s41, 0x80000000, s41
    s_waitcnt vmcnt(0)
    s_branch C_round
B_spin0:
    s_sub_u32 s36, s36, 1
    s_cbranch_scc1 B_spun0
    s_sleep 1
    ds_read_b32 v14, v215
    s_branch B_chk0
B_spun0:
    s_mov_b32 s36, 0
    s_branch B_chkd0
B_spin1:
    s_sub_u32 s36, s36, 1
    s_cbranch_scc1 B_spun1
    s_sleep 1
    ds_read_b32 v14, v231
    s_branch B_chk1
B_spun1:
    s_mov_b32 s36, 0
    s_branch B_chkd1
B_spin2:
    s_sub_u32 s36, s36, 1
    s_cbranch_scc1 B_spun2
    s_sleep 1
    ds_read_b32 v14, v231
    s_branch B_chk2
B_spun2:
    s_mov_b32 s36, 0
    s_branch B_chkd2
B_spin3:
    s_sub_u32 s36, s36, 1
    s_cbranch_scc1 B_spun3
    s_sleep 1
    ds_read_b32 v14, v231
    s_branch B_chk3
B_spun3:
    s_mov_b32 s36, 0
    s_branch B_chkd3
B_spin4:
    s_sub_u32 s36, s36, 1
    s_cbranch_scc1 B_spun4
    s_sleep 1
    ds_read_b32 v14, v231
    s_branch B_chk4
B_spun4:
    s_mov_b32 s36, 0
    s_branch B_chkd4
B_spin5:
    s_sub_u32 s36, s36, 1
    s_cbranch_scc1 B_spun5
    s_sleep 1
    ds_read_b32 v14, v231
    s_branch B_chk5
B_spun5:
    s_mov_b32 s36, 0
    s_branch B_chkd5
B_spin6:
    s_sub_u32 s36, s36, 1
    s_cbranch_scc1 B_spun6
    s_sleep 1
    ds_read_b32 v14, v231
    s_branch B_chk6
B_spun6:
    s_mov_b32 s36, 0
    s_branch B_chkd6
B_spin7:
    s_sub_u32 s36, s36, 1
    s_cbranch_scc1 B_spun7
    s_sleep 1
    ds_read_b32 v14, v231
    s_branch B_chk7
B_spun7:
    s_mov_b32 s36, 0
    s_branch B_chkd7
B_ff0:
    s_cmp_eq_u32 s23, 2
    s_cbranch_scc1 B_ffb0
    s_add_u32 m0, s47, 0
    s_mov_b32 s42, 0
    buffer_load_dwordx4 v217, s[64:67], s42 offen lds
    s_branch B_ffd0
B_ffb0:
    s_mov_b32 m0, s47
    s_mov_b32 s42, 0
    buffer_load_dwordx4 v217, s[60:63], s42 offen lds
    s_mov_b32 s42, 39936
    buffer_load_dwordx4 v217, s[60:63], s42 offen offset:1024 lds
    s_branch B_ffd0
B_f2r0:
    s_waitcnt vmcnt(0)
    ds_read_b64_tr_b16 v[128:129], v222 offset:0
    ds_read_b64_tr_b16 v[130:131], v222 offset:128
    ds_read_b64_tr_b16 v[132:133], v222 offset:1024
    ds_read_b64_tr_b16 v[134:135], v222 offset:1152
    s_branch B_f2d0
B_ff1:
    s_cmp_eq_u32 s23, 2
    s_cbranch_scc1 B_ffb1
    s_add_u32 m0, s47, 4096
    s_mov_b32 s42, 786432
    buffer_load_dwordx4 v217, s[64:67], s42 offen lds
    s_branch B_ffd1
B_ffb1:
    s_mov_b32 m0, s47
    s_mov_b32 s42, 81920
    buffer_load_dwordx4 v217, s[60:63], s42 offen lds
    s_mov_b32 s42, 121856
    buffer_load_dwordx4 v217, s[60:63], s42 offen offset:1024 lds
    s_branch B_ffd1
B_f2r1:
    s_waitcnt vmcnt(0)
    ds_read_b64_tr_b16 v[136:137], v222 offset:0
    ds_read_b64_tr_b16 v[138:139], v222 offset:128
    ds_read_b64_tr_b16 v[140:141], v222 offset:1024
    ds_read_b64_tr_b16 v[142:143], v222 offset:1152
    s_branch B_f2d1
B_ff2:
    s_cmp_eq_u32 s23, 2
    s_cbranch_scc1 B_ffb2
    s_cmp_ge_u32 s31, 2
    s_cbranch_scc1 B_ffd2
    s_add_u32 m0, s47, 8192
    s_mov_b32 s42, 1572864
    buffer_load_dwordx4 v217, s[64:67], s42 offen lds
    s_branch B_ffd2
B_ffb2:
    s_mov_b32 m0, s47
    s_mov_b32 s42, 163840
    buffer_load_dwordx4 v217, s[60:63], s42 offen lds
    s_mov_b32 s42, 203776
    buffer_load_dwordx4 v217, s[60:63], s42 offen offset:1024 lds
    s_branch B_ffd2
B_f2r2:
    s_waitcnt vmcnt(0)
    ds_read_b64_tr_b16 v[144:145], v222 offset:0
    ds_read_b64_tr_b16 v[146:147], v222 offset:128
    ds_read_b64_tr_b16 v[148:149], v222 offset:1024
    ds_read_b64_tr_b16 v[150:151], v222 offset:1152
    s_branch B_f2d2
B_mark:
    s_lshl_b32 s42, s33, 13
    s_lshl_b32 s43, s32, 2
    s_add_u32 s42, s42, s43
    s_add_u32 s42, s42, 11534848
    s_mov_b64 exec, 1
    s_cmp_eq_u32 s3, 0
    s_cbranch_scc1 B_mark2
    buffer_store_dword v227, off, s[16:19], s42
    s_mov_b64 exec, -1
    s_branch B_markd
B_mark2:
    buffer_store_dword v227, off, s[16:19], s42 sc1
    s_mov_b64 exec, -1
    s_branch B_markd
B_col:
    s_lshl_b32 s24, s33, 13
    s_add_u32 s24, s24, 11534848
    v_and_b32 v12, 0x7c, v216
    buffer_load_dword v11, v12, s[16:19], s24 offen sc1
    s_branch B_cold
B_col2:
    s_waitcnt vmcnt(0)
    v_cmp_eq_u32 vcc, 0, v11
    s_cbranch_vccz B_col3
    s_sub_u32 s36, s36, 1
    s_cbranch_scc1 B_col4
    buffer_load_dword v11, v12, s[16:19], s24 offen sc1
    s_branch B_col2
B_col4:
    s_mov_b32 s36, 0
B_col3:
    s_lshl_b32 s42, s33, 2
    s_mov_b64 exec, 1
    buffer_store_dword v227, off, s[12:15], s42 offset:128 sc1
    s_mov_b64 exec, -1
    s_branch B_col2d
C_again:
    s_sub_u32 s36, s36, 1
    s_cbranch_scc1 C_chkd
    buffer_load_dword v11, v238, s[12:15], 0 offen offset:128 sc1
    s_waitcnt vmcnt(0)
    s_branch C_chk
B_slowpub:
    buffer_wbl2 sc1
    s_waitcnt vmcnt(0)
    buffer_store_dword v227, off, s[16:19], s42 sc1
    s_branch B_pubd
C_slowst:
    buffer_store_dword v20, v3, s[16:19], s43 offen sc1
    s_branch C_std
B_fallback:
    s_mul_i32 s41, s40, 2560
    s_add_u32 s41, s41, s27
    v_and_b32 v12, 31, v0
    v_lshlrev_b32 v12, 4, v12
    s_lshl_b32 s43, s26, 3
    v_add_u32 v12, s43, v12
    buffer_load_dwordx2 v[88:89], v12, s[16:19], s41 offen offset:1024
    buffer_load_dwordx4 v[80:83], v208, s[16:19], s41 offen
    v_mov_b32 v14, 0xff800000
    s_mov_b32 s46, 0
    s_mov_b32 s47, s28
B_fb_max:
    buffer_load_dwordx2 v[90:91], v209, s[16:19], s47 offen
    buffer_load_dwordx4 v[98:101], v208, s[16:19], s47 offen
    buffer_load_dwordx4 v[102:105], v208, s[16:19], s47 offen offset:2560
    s_waitcnt vmcnt(0)
    v_mfma_f32_32x32x4_2b_bf16 v[16:47], v[90:91], v[88:89], 0
    s_nop 15
    s_nop 1
    v_mfma_f32_32x32x16_bf16 v[16:31], v[98:101], v[80:83], v[16:31]
    v_mfma_f32_32x32x16_bf16 v[32:47], v[102:105], v[80:83], v[32:47]
    s_nop 10
    v_max3_f32 v14, v14, v16, v17
    v_max3_f32 v14, v14, v18, v19
    v_max3_f32 v14, v14, v20, v21
    v_max3_f32 v14, v14, v22, v23
    v_max3_f32 v14, v14, v24, v25
    v_max3_f32 v14, v14, v26, v27
    v_max3_f32 v14, v14, v28, v29
    v_max3_f32 v14, v14, v30, v31
    v_max3_f32 v14, v14, v32, v33
    v_max3_f32 v14, v14, v34, v35
    v_max3_f32 v14, v14, v36, v37
    v_max3_f32 v14, v14, v38, v39
    v_max3_f32 v14, v14, v40, v41
    v_max3_f32 v14, v14, v42, v43
    v_max3_f32 v14, v14, v44, v45
    v_max3_f32 v14, v14, v46, v47
    s_add_u32 s47, s47, 5120
    s_add_u32 s46, s46, 1
    s_cmp_lt_u32 s46, 32
    s_cbranch_scc1 B_fb_max
    v_mov_b32 v12, v14
    s_nop 1
    v_permlane32_swap_b32 v12, v14
    v_max_f32 v14, v12, v14
    v_mov_b32 v192, 0
    v_mov_b32 v193, 0
    v_mov_b32 v194, 0
    v_mov_b32 v195, 0
    v_mov_b32 v196, 0
    v_mov_b32 v197, 0
    v_mov_b32 v198, 0
    v_mov_b32 v199, 0
    v_mov_b32 v200, 0
    v_mov_b32 v201, 0
    v_mov_b32 v202, 0
    v_mov_b32 v203, 0
    v_mov_b32 v204, 0
    v_mov_b32 v205, 0
    v_mov_b32 v206, 0
    v_mov_b32 v207, 0
    s_mov_b32 s46, 0
    s_mov_b32 s47, s28
    s_mov_b32 s43, s29
B_fb_pv:
    buffer_load_dwordx2 v[90:91], v209, s[16:19], s47 offen
    buffer_load_dwordx4 v[98:101], v208, s[16:19], s47 offen
    buffer_load_dwordx4 v[102:105], v208, s[16:19], s47 offen offset:2560
    s_mov_b64 exec, s[44:45]
    buffer_load_dwordx4 v[160:163], v210, s[16:19], s43 offen offset:0
    buffer_load_dwordx4 v[164:167], v210, s[16:19], s43 offen offset:640
    buffer_load_dwordx4 v[168:171], v210, s[16:19], s43 offen offset:1280
    buffer_load_dwordx4 v[172:175], v210, s[16:19], s43 offen offset:1920
    s_mov_b64 exec, -1
    s_waitcnt vmcnt(0)
    v_mfma_f32_32x32x4_2b_bf16 v[16:47], v[90:91], v[88:89], 0
    s_nop 15
    s_nop 1
    v_mfma_f32_32x32x16_bf16 v[16:31], v[98:101], v[80:83], v[16:31]
    v_mfma_f32_32x32x16_bf16 v[32:47], v[102:105], v[80:83], v[32:47]
    s_nop 10
    v_sub_f32 v16, v16, v14
    v_sub_f32 v17, v17, v14
    v_sub_f32 v18, v18, v14
    v_sub_f32 v19, v19, v14
    v_sub_f32 v20, v20, v14
    v_sub_f32 v21, v21, v14
    v_sub_f32 v22, v22, v14
    v_sub_f32 v23, v23, v14
    v_sub_f32 v24, v24, v14
    v_sub_f32 v25, v25, v14
    v_sub_f32 v26, v26, v14
    v_sub_f32 v27, v27, v14
    v_sub_f32 v28, v28, v14
    v_sub_f32 v29, v29, v14
    v_sub_f32 v30, v30, v14
    v_sub_f32 v31, v31, v14
    v_sub_f32 v32, v32, v14
    v_sub_f32 v33, v33, v14
    v_sub_f32 v34, v34, v14
    v_sub_f32 v35, v35, v14
    v_sub_f32 v36, v36, v14
    v_sub_f32 v37, v37, v14
    v_sub_f32 v38, v38, v14
    v_sub_f32 v39, v39, v14
    v_sub_f32 v40, v40, v14
    v_sub_f32 v41, v41, v14
    v_sub_f32 v42, v42, v14
    v_sub_f32 v43, v43, v14
    v_sub_f32 v44, v44, v14
    v_sub_f32 v45, v45, v14
    v_sub_f32 v46, v46, v14
    v_sub_f32 v47, v47, v14
    v_exp_f32 v16, v16
    v_exp_f32 v17, v17
    v_exp_f32 v18, v18
    v_exp_f32 v19, v19
    v_exp_f32 v20, v20
    v_exp_f32 v21, v21
    v_exp_f32 v22, v22
    v_exp_f32 v23, v23
    v_exp_f32 v24, v24
    v_exp_f32 v25, v25
    v_exp_f32 v26, v26
    v_exp_f32 v27, v27
    v_exp_f32 v28, v28
    v_exp_f32 v29, v29
    v_exp_f32 v30, v30
    v_exp_f32 v31, v31
    v_exp_f32 v32, v32
    v_exp_f32 v33, v33
    v_exp_f32 v34, v34
    v_exp_f32 v35, v35
    v_exp_f32 v36, v36
    v_exp_f32 v37, v37
    v_exp_f32 v38, v38
    v_exp_f32 v39, v39
    v_exp_f32 v40, v40
    v_exp_f32 v41, v41
    v_exp_f32 v42, v42
    v_exp_f32 v43, v43
    v_exp_f32 v44, v44
    v_exp_f32 v45, v45
    v_exp_f32 v46, v46
    v_exp_f32 v47, v47
    v_smfmac_f32_32x32x32_bf16 v[192:207], v[160:163], v[16:23], v211
    v_smfmac_f32_32x32x32_bf16 v[192:207], v[164:167], v[24:31], v211
    v_smfmac_f32_32x32x32_bf16 v[192:207], v[168:171], v[32:39], v211
    v_smfmac_f32_32x32x32_bf16 v[192:207], v[172:175], v[40:47], v211
    s_add_u32 s47, s47, 5120
    s_add_u32 s43, s43, 2560
    s_add_u32 s46, s46, 1
    s_cmp_lt_u32 s46, 32
    s_cbranch_scc1 B_fb_pv
    s_nop 7
    v_rcp_f32 v12, v202
    s_nop 0
    s_branch B_fin
L_end:
    s_endpgm
.section .rodata,"a"
.p2align 6
.amdhsa_kernel sequential_preLN__mha_block__moe_arch_mod__prompt_kernel
  .amdhsa_next_free_vgpr 256
  .amdhsa_next_free_sgpr 102
  .amdhsa_accum_offset 256
  .amdhsa_group_segment_fixed_size 0
  .amdhsa_kernarg_size 88
  .amdhsa_user_sgpr_count 2
  .amdhsa_user_sgpr_kernarg_segment_ptr 1
  .amdhsa_system_sgpr_workgroup_id_x 1
.end_amdhsa_kernel
```
